```python
import torch

def _softmax(x, axis=-1):
    return torch.softmax(x, dim=axis)
def _gelu(x):
    return torch.nn.functional.gelu(x, approximate="tanh")
def _silu(x):
    return torch.nn.functional.silu(x)
def _sigmoid(x):
    return torch.sigmoid(x)
def _layernorm(x, axis=-1, eps=1e-5):
    m = x.mean(dim=axis, keepdim=True)
    v = x.var(dim=axis, keepdim=True, unbiased=False)
    return (x - m) / torch.sqrt(v + eps)
def _scatter_add(tgt, idx, src, axis=0):
    return tgt.clone().index_add_(axis, idx, src)
def _segment_sum(src, seg, n):
    out = torch.zeros((n,) + src.shape[1:], dtype=src.dtype)
    return out.index_add_(0, seg, src)
def _pad(x, pw):
    flat = tuple(v for pair in reversed(pw) for v in pair)
    return torch.nn.functional.pad(x, flat)

kernel_name = 'standalone__geglu_ffn__prompt'

def setup_inputs():

    _w = (lambda a: (lambda t: t.to(torch.bfloat16) if t.is_floating_point() else t)(torch.as_tensor(a)))
    B, S, D, F = 1, 2048, 448, 1792
    return {
        "x": _w((lambda *s: torch.randn(*s, dtype=torch.bfloat16) * 0.05)(B, S, D)),
        "w_gate": _w((lambda *s: torch.randn(*s, dtype=torch.bfloat16) * 0.05)(D, F)),
        "w_up": _w((lambda *s: torch.randn(*s, dtype=torch.bfloat16) * 0.05)(D, F)),
        "w_down": _w((lambda *s: torch.randn(*s, dtype=torch.bfloat16) * 0.05)(F, D)),
    }

def reference(x, w_gate, w_up, w_down):
    return (_gelu(x @ w_gate) * (x @ w_up)) @ w_down
```

```asm
; @launch grid=(256,1,1) block=(512,1,1) lds=163840
.amdgcn_target "amdgcn-amd-amdhsa--gfx950"
.text
.globl standalone__geglu_ffn__prompt_kernel
.p2align 8
.type standalone__geglu_ffn__prompt_kernel,@function
standalone__geglu_ffn__prompt_kernel:
    s_cmp_gt_u32 s2, 255
    s_cbranch_scc1 L_done
    s_load_dwordx8 s[4:11], s[0:1], 0
    s_load_dwordx4 s[12:15], s[0:1], 32
    s_load_dwordx2 s[16:17], s[0:1], 48
    s_getpc_b64 s[18:19]
L_pc:
    v_lshrrev_b32 v36, 6, v0
    v_and_b32 v0, 63, v0
    s_cmp_lt_u32 s2, 32
    v_readfirstlane_b32 s44, v36
    s_cbranch_scc1 L_helper
    v_lshlrev_b32 v37, 6, v0
    s_lshl_b32 s55, s44, 12
    v_add_u32 v37, s55, v37
    v_min_u32 v37, L_end-L_pc-4, v37
    global_load_dword v38, v37, s[18:19]
    s_and_b32 s55, s2, 7
    s_lshr_b32 s56, s2, 3
    s_sub_u32 s56, s56, 4
    s_and_b32 s57, s56, 3
    s_lshr_b32 s49, s56, 2
    s_lshl_b32 s48, s55, 2
    s_add_u32 s48, s48, s57
    s_and_b32 s57, s55, 3
    s_mul_i32 s57, s57, 28
    s_add_u32 s57, s57, s56
    s_lshr_b32 s47, s57, 3
    s_and_b32 s46, s57, 7
    s_lshr_b32 s57, s55, 2
    s_lshl_b32 s57, s57, 3
    s_add_u32 s46, s46, s57
    s_and_b32 s45, s44, 3
    s_and_b32 s62, s44, 1
    s_bfe_u32 s63, s44, 0x10001
    v_lshrrev_b32 v44, 3, v0
    v_and_b32 v45, 7, v0
    v_lshrrev_b32 v46, 4, v0
    v_xor_b32 v46, v45, v46
    v_mul_u32_u24 v47, 896, v44
    v_lshl_add_u32 v1, v46, 4, v47
    v_xor_b32 v46, 4, v46
    v_add_u32 v47, 6144, v47
    v_lshl_add_u32 v2, v46, 4, v47
    v_lshrrev_b32 v46, 1, v45
    v_bfe_u32 v47, v44, 1, 1
    v_xor_b32 v46, v46, v47
    v_and_b32 v47, 1, v45
    v_lshlrev_b32 v47, 4, v47
    v_mul_u32_u24 v48, 3584, v44
    v_add_u32 v48, v48, v47
    v_lshl_add_u32 v3, v46, 5, v48
    v_add_u32 v4, 26624, v3
    v_xor_b32 v5, 64, v3
    v_add_u32 v6, 26624, v5
    s_lshl_b32 s50, s46, 7
    s_lshl_b32 s55, s45, 5
    s_add_u32 s50, s50, s55
    s_mul_i32 s50, s50, 896
    s_mul_i32 s51, s45, 57344
    s_lshl_b32 s55, s47, 8
    s_add_u32 s51, s51, s55
    s_lshl_b32 s52, s45, 12
    s_and_b32 s3, s46, 3
    s_lshl_b32 s3, s3, 1
    s_add_u32 s3, s3, s47
    s_cmp_ge_u32 s3, 6
    s_cselect_b32 s56, 6, 0
    s_sub_u32 s3, s3, s56
    s_cmp_ge_u32 s3, 6
    s_cselect_b32 s56, 6, 0
    s_sub_u32 s3, s3, s56
    s_cmp_ge_u32 s3, 6
    s_cselect_b32 s56, 6, 0
    s_sub_u32 s3, s3, s56
    s_mov_b32 s100, 0
    s_and_b32 s64, s48, 3
    s_lshl_b32 s64, s64, 1
    s_add_u32 s64, s64, s49
    s_cmp_ge_u32 s64, 7
    s_cselect_b32 s56, 7, 0
    s_sub_u32 s64, s64, s56
    s_cmp_ge_u32 s64, 7
    s_cselect_b32 s56, 7, 0
    s_sub_u32 s64, s64, s56
    s_add_u32 s65, s64, 1
    s_cmp_ge_u32 s65, 7
    s_cselect_b32 s65, 0, s65
    s_add_u32 s66, s65, 1
    s_cmp_ge_u32 s66, 7
    s_cselect_b32 s66, 0, s66
    s_add_u32 s67, s66, 1
    s_cmp_ge_u32 s67, 7
    s_cselect_b32 s67, 0, s67
    s_add_u32 s68, s67, 1
    s_cmp_ge_u32 s68, 7
    s_cselect_b32 s68, 0, s68
    s_add_u32 s69, s68, 1
    s_cmp_ge_u32 s69, 7
    s_cselect_b32 s69, 0, s69
    s_add_u32 s70, s69, 1
    s_cmp_ge_u32 s70, 7
    s_cselect_b32 s70, 0, s70
    s_waitcnt lgkmcnt(0)
    s_mov_b32 s20, s4
    s_and_b32 s21, s5, 0xffff
    s_mov_b32 s22, 0x1c0000
    s_mov_b32 s23, 0x20000
    s_mov_b32 s24, s6
    s_and_b32 s25, s7, 0xffff
    s_mov_b32 s26, 0x188000
    s_mov_b32 s27, 0x20000
    s_mov_b32 s28, s8
    s_and_b32 s29, s9, 0xffff
    s_mov_b32 s30, 0x188000
    s_mov_b32 s31, 0x20000
    s_cmp_ge_u32 s44, 4
    s_cbranch_scc1 L_B
    s_add_u32 m0, s52, 0
    s_mul_i32 s58, s100, 128
    s_add_u32 s58, s58, s50
    buffer_load_dwordx4 v1, s[20:23], s58 offen lds
    buffer_load_dwordx4 v2, s[20:23], s58 offen offset:1024 lds
    s_add_u32 m0, s52, 2048
    s_mul_i32 s58, s100, 128
    s_add_u32 s58, s58, s50
    s_add_u32 s58, s58, 14336
    buffer_load_dwordx4 v1, s[20:23], s58 offen lds
    buffer_load_dwordx4 v2, s[20:23], s58 offen offset:1024 lds
    s_mov_b32 s32, s16
    s_and_b32 s33, s17, 0xffff
    s_mov_b32 s34, 0x10000000
    s_mov_b32 s35, 0x20000
    s_mov_b32 s36, s10
    s_and_b32 s37, s11, 0xffff
    s_mov_b32 s38, 0x188000
    s_mov_b32 s39, 0x20000
    s_mov_b32 s40, s12
    s_and_b32 s41, s13, 0xffff
    s_mov_b32 s42, 0x1c0000
    s_mov_b32 s43, 0x20000
    s_add_u32 s5, s3, 1
    s_mov_b32 s4, 0
    s_add_u32 s6, s5, 1
    s_cmp_ge_u32 s6, 7
    s_cselect_b32 s6, 1, s6
    s_add_u32 s7, s6, 1
    s_cmp_ge_u32 s7, 7
    s_cselect_b32 s7, 1, s7
    s_add_u32 s8, s7, 1
    s_cmp_ge_u32 s8, 7
    s_cselect_b32 s8, 1, s8
    s_add_u32 s9, s8, 1
    s_cmp_ge_u32 s9, 7
    s_cselect_b32 s9, 1, s9
    s_add_u32 s10, s9, 1
    s_cmp_ge_u32 s10, 7
    s_cselect_b32 s10, 1, s10
    s_add_u32 m0, s52, 16384
    s_mul_i32 s58, s5, 128
    s_add_u32 s58, s58, s50
    buffer_load_dwordx4 v1, s[20:23], s58 offen lds
    buffer_load_dwordx4 v2, s[20:23], s58 offen offset:1024 lds
    s_add_u32 m0, s52, 18432
    s_mul_i32 s58, s5, 128
    s_add_u32 s58, s58, s50
    s_add_u32 s58, s58, 14336
    buffer_load_dwordx4 v1, s[20:23], s58 offen lds
    buffer_load_dwordx4 v2, s[20:23], s58 offen offset:1024 lds
    s_add_u32 m0, s52, 32768
    s_mul_i32 s58, s6, 128
    s_add_u32 s58, s58, s50
    buffer_load_dwordx4 v1, s[20:23], s58 offen lds
    buffer_load_dwordx4 v2, s[20:23], s58 offen offset:1024 lds
    s_add_u32 m0, s52, 34816
    s_mul_i32 s58, s6, 128
    s_add_u32 s58, s58, s50
    s_add_u32 s58, s58, 14336
    buffer_load_dwordx4 v1, s[20:23], s58 offen lds
    buffer_load_dwordx4 v2, s[20:23], s58 offen offset:1024 lds
    v_lshrrev_b32 v44, 5, v0
    v_lshlrev_b32 v44, 11, v44
    v_bfe_u32 v45, v0, 4, 1
    v_lshl_add_u32 v44, v45, 10, v44
    v_bfe_u32 v46, v0, 2, 2
    v_lshl_add_u32 v44, v46, 7, v44
    v_and_b32 v47, 3, v0
    v_lshl_add_u32 v44, v47, 3, v44
    v_lshrrev_b32 v46, 1, v46
    v_lshl_or_b32 v46, v45, 1, v46
    v_lshl_add_u32 v15, v46, 5, v44
    v_xor_b32 v16, 32, v15
    v_xor_b32 v17, 64, v15
    v_xor_b32 v18, 96, v15
    v_add_u32 v19, 0x10000, v15
    v_add_u32 v20, 0x10000, v16
    v_add_u32 v21, 0x10000, v17
    v_add_u32 v22, 0x10000, v18
    v_add_u32 v23, 0x20000, v15
    v_add_u32 v24, 0x20000, v16
    v_add_u32 v25, 0x20000, v17
    v_add_u32 v26, 0x20000, v18
    v_and_b32 v44, 31, v0
    v_bfe_u32 v45, v0, 1, 3
    v_lshrrev_b32 v46, 5, v0
    v_xor_b32 v45, v45, v46
    v_lshlrev_b32 v44, 7, v44
    v_lshl_add_u32 v44, v45, 4, v44
    v_add_u32 v27, s52, v44
    v_xor_b32 v28, 32, v27
    v_xor_b32 v29, 64, v27
    v_xor_b32 v30, 96, v27
    v_add_u32 v31, 0x10000, v27
    v_add_u32 v32, 0x10000, v28
    v_add_u32 v33, 0x10000, v29
    v_add_u32 v34, 0x10000, v30
    v_lshlrev_b32 v9, 4, v0
    v_mov_b32 v10, 0xbdd2d3e8
    s_mov_b32 s54, 0xc0135761
    s_lshl_b32 s56, s46, 2
    s_add_u32 s56, s56, s45
    s_mul_i32 s53, s56, 112
    s_lshl_b32 s55, s47, 3
    s_add_u32 s53, s53, s55
    s_and_b32 s55, s44, 4
    s_add_u32 s53, s53, s55
    s_lshl_b32 s53, s53, 10
    s_lshl_b32 s56, s56, 8
    s_lshl_b32 s55, s47, 2
    s_add_u32 s56, s56, s55
    s_add_u32 s56, s56, 0x800000
    v_mov_b32 v11, s56
    v_lshrrev_b32 v44, 3, v0
    v_and_b32 v45, 7, v0
    v_lshrrev_b32 v46, 2, v45
    v_bfe_u32 v47, v44, 1, 1
    v_xor_b32 v46, v46, v47
    v_and_b32 v47, 3, v45
    v_lshl_add_u32 v47, v46, 2, v47
    v_lshlrev_b32 v47, 4, v47
    v_mul_u32_u24 v48, 896, v44
    v_add_u32 v7, v48, v47
    v_add_u32 v8, 6144, v7
    s_lshl_b32 s59, s63, 7
    s_lshl_b32 s55, s62, 5
    s_add_u32 s59, s59, s55
    s_mul_i32 s59, s59, 896
    s_lshl_b32 s55, s49, 7
    s_add_u32 s59, s59, s55
    v_lshrrev_b32 v44, 5, v0
    v_lshlrev_b32 v44, 9, v44
    v_bfe_u32 v45, v0, 2, 2
    v_lshl_add_u32 v44, v45, 7, v44
    v_bfe_u32 v46, v0, 4, 1
    v_lshl_add_u32 v44, v46, 5, v44
    v_and_b32 v46, 3, v0
    v_lshl_add_u32 v44, v46, 3, v44
    s_lshl_b32 s55, s63, 13
    v_add_u32 v44, s55, v44
    v_lshrrev_b32 v45, 1, v45
    v_lshl_add_u32 v35, v45, 6, v44
    s_lshl_b32 s56, s48, 1
    s_add_u32 s56, s56, s62
    s_mul_i32 s60, s56, 112
    s_lshl_b32 s55, s63, 3
    s_add_u32 s60, s60, s55
    s_and_b32 s55, s44, 4
    s_add_u32 s60, s60, s55
    s_lshl_b32 s60, s60, 10
    s_lshl_b32 s56, s56, 8
    s_lshl_b32 s55, s63, 2
    s_add_u32 s56, s56, s55
    s_add_u32 s56, s56, 0x800000
    v_lshlrev_b32 v44, 3, v0
    v_add_u32 v12, s56, v44
    s_waitcnt vmcnt(8)
    s_barrier
    ds_read_b128 v[144:147], v27 offset:0
    ds_read_b64_tr_b16 v[36:37], v19 offset:16384
    ds_read_b64_tr_b16 v[38:39], v19 offset:16896
    ds_read_b64_tr_b16 v[40:41], v20 offset:16384
    ds_read_b64_tr_b16 v[42:43], v20 offset:16896
    ds_read_b64_tr_b16 v[44:45], v21 offset:16384
    ds_read_b64_tr_b16 v[46:47], v21 offset:16896
    ds_read_b64_tr_b16 v[48:49], v22 offset:16384
    ds_read_b64_tr_b16 v[50:51], v22 offset:16896
    ds_read_b128 v[148:151], v28 offset:0
    ds_read_b64_tr_b16 v[52:53], v19 offset:20480
    ds_read_b64_tr_b16 v[54:55], v19 offset:20992
    ds_read_b64_tr_b16 v[56:57], v20 offset:20480
    ds_read_b64_tr_b16 v[58:59], v20 offset:20992
    s_waitcnt lgkmcnt(11)
    v_mfma_f32_32x32x16_bf16 v[68:83], v[36:39], v[144:147], 0
    ds_read_b64_tr_b16 v[60:61], v21 offset:20480
    ds_read_b64_tr_b16 v[62:63], v21 offset:20992
    s_waitcnt lgkmcnt(11)
    v_mfma_f32_32x32x16_bf16 v[84:99], v[40:43], v[144:147], 0
    ds_read_b64_tr_b16 v[36:37], v22 offset:20480
    ds_read_b64_tr_b16 v[38:39], v22 offset:20992
    s_waitcnt lgkmcnt(11)
    v_mfma_f32_32x32x16_bf16 v[100:115], v[44:47], v[144:147], 0
    ds_read_b128 v[152:155], v29 offset:0
    ds_read_b64_tr_b16 v[40:41], v19 offset:24576
    ds_read_b64_tr_b16 v[42:43], v19 offset:25088
    s_waitcnt lgkmcnt(12)
    v_mfma_f32_32x32x16_bf16 v[116:131], v[48:51], v[144:147], 0
    ds_read_b64_tr_b16 v[44:45], v20 offset:24576
    ds_read_b64_tr_b16 v[46:47], v20 offset:25088
    s_waitcnt lgkmcnt(11)
    v_mfma_f32_32x32x16_bf16 v[68:83], v[52:55], v[148:151], v[68:83]
    ds_read_b64_tr_b16 v[48:49], v21 offset:24576
    ds_read_b64_tr_b16 v[50:51], v21 offset:25088
    s_waitcnt lgkmcnt(11)
    v_mfma_f32_32x32x16_bf16 v[84:99], v[56:59], v[148:151], v[84:99]
    ds_read_b64_tr_b16 v[52:53], v22 offset:24576
    ds_read_b64_tr_b16 v[54:55], v22 offset:25088
    s_waitcnt lgkmcnt(11)
    v_mfma_f32_32x32x16_bf16 v[100:115], v[60:63], v[148:151], v[100:115]
    ds_read_b128 v[156:159], v30 offset:0
    ds_read_b64_tr_b16 v[56:57], v19 offset:28672
    ds_read_b64_tr_b16 v[58:59], v19 offset:29184
    s_waitcnt lgkmcnt(12)
    v_mfma_f32_32x32x16_bf16 v[116:131], v[36:39], v[148:151], v[116:131]
    ds_read_b64_tr_b16 v[60:61], v20 offset:28672
    ds_read_b64_tr_b16 v[62:63], v20 offset:29184
    s_waitcnt lgkmcnt(11)
    v_mfma_f32_32x32x16_bf16 v[68:83], v[40:43], v[152:155], v[68:83]
    ds_read_b64_tr_b16 v[36:37], v21 offset:28672
    ds_read_b64_tr_b16 v[38:39], v21 offset:29184
    s_waitcnt lgkmcnt(11)
    v_mfma_f32_32x32x16_bf16 v[84:99], v[44:47], v[152:155], v[84:99]
    ds_read_b64_tr_b16 v[40:41], v22 offset:28672
    ds_read_b64_tr_b16 v[42:43], v22 offset:29184
    s_waitcnt lgkmcnt(11)
    v_mfma_f32_32x32x16_bf16 v[100:115], v[48:51], v[152:155], v[100:115]
    s_waitcnt vmcnt(4)
    s_barrier
    ds_read_b128 v[144:147], v27 offset:16384
    ds_read_b64_tr_b16 v[44:45], v19 offset:32768
    ds_read_b64_tr_b16 v[46:47], v19 offset:33280
    s_waitcnt lgkmcnt(12)
    v_mfma_f32_32x32x16_bf16 v[116:131], v[52:55], v[152:155], v[116:131]
    ds_read_b64_tr_b16 v[48:49], v20 offset:32768
    ds_read_b64_tr_b16 v[50:51], v20 offset:33280
    s_waitcnt lgkmcnt(11)
    v_mfma_f32_32x32x16_bf16 v[68:83], v[56:59], v[156:159], v[68:83]
    ds_read_b64_tr_b16 v[52:53], v21 offset:32768
    ds_read_b64_tr_b16 v[54:55], v21 offset:33280
    s_waitcnt lgkmcnt(11)
    v_mfma_f32_32x32x16_bf16 v[84:99], v[60:63], v[156:159], v[84:99]
    ds_read_b64_tr_b16 v[56:57], v22 offset:32768
    ds_read_b64_tr_b16 v[58:59], v22 offset:33280
    s_waitcnt lgkmcnt(11)
    v_mfma_f32_32x32x16_bf16 v[100:115], v[36:39], v[156:159], v[100:115]
    ds_read_b128 v[148:151], v28 offset:16384
    ds_read_b64_tr_b16 v[60:61], v19 offset:36864
    ds_read_b64_tr_b16 v[62:63], v19 offset:37376
    s_waitcnt lgkmcnt(12)
    v_mfma_f32_32x32x16_bf16 v[116:131], v[40:43], v[156:159], v[116:131]
    ds_read_b64_tr_b16 v[36:37], v20 offset:36864
    ds_read_b64_tr_b16 v[38:39], v20 offset:37376
    s_waitcnt lgkmcnt(11)
    v_mfma_f32_32x32x16_bf16 v[68:83], v[44:47], v[144:147], v[68:83]
    ds_read_b64_tr_b16 v[40:41], v21 offset:36864
    ds_read_b64_tr_b16 v[42:43], v21 offset:37376
    s_waitcnt lgkmcnt(11)
    v_mfma_f32_32x32x16_bf16 v[84:99], v[48:51], v[144:147], v[84:99]
    ds_read_b64_tr_b16 v[44:45], v22 offset:36864
    ds_read_b64_tr_b16 v[46:47], v22 offset:37376
    s_waitcnt lgkmcnt(11)
    v_mfma_f32_32x32x16_bf16 v[100:115], v[52:55], v[144:147], v[100:115]
    ds_read_b128 v[152:155], v29 offset:16384
    ds_read_b64_tr_b16 v[48:49], v19 offset:40960
    ds_read_b64_tr_b16 v[50:51], v19 offset:41472
    s_waitcnt lgkmcnt(12)
    v_mfma_f32_32x32x16_bf16 v[116:131], v[56:59], v[144:147], v[116:131]
    ds_read_b64_tr_b16 v[52:53], v20 offset:40960
    ds_read_b64_tr_b16 v[54:55], v20 offset:41472
    s_waitcnt lgkmcnt(11)
    v_mfma_f32_32x32x16_bf16 v[68:83], v[60:63], v[148:151], v[68:83]
    ds_read_b64_tr_b16 v[56:57], v21 offset:40960
    ds_read_b64_tr_b16 v[58:59], v21 offset:41472
    s_waitcnt lgkmcnt(11)
    v_mfma_f32_32x32x16_bf16 v[84:99], v[36:39], v[148:151], v[84:99]
    ds_read_b64_tr_b16 v[60:61], v22 offset:40960
    ds_read_b64_tr_b16 v[62:63], v22 offset:41472
    s_waitcnt lgkmcnt(11)
    v_mfma_f32_32x32x16_bf16 v[100:115], v[40:43], v[148:151], v[100:115]
    ds_read_b128 v[156:159], v30 offset:16384
    ds_read_b64_tr_b16 v[36:37], v19 offset:45056
    ds_read_b64_tr_b16 v[38:39], v19 offset:45568
    s_waitcnt lgkmcnt(12)
    v_mfma_f32_32x32x16_bf16 v[116:131], v[44:47], v[148:151], v[116:131]
    ds_read_b64_tr_b16 v[40:41], v20 offset:45056
    ds_read_b64_tr_b16 v[42:43], v20 offset:45568
    s_waitcnt lgkmcnt(11)
    v_mfma_f32_32x32x16_bf16 v[68:83], v[48:51], v[152:155], v[68:83]
    ds_read_b64_tr_b16 v[44:45], v21 offset:45056
    ds_read_b64_tr_b16 v[46:47], v21 offset:45568
    s_waitcnt lgkmcnt(11)
    v_mfma_f32_32x32x16_bf16 v[84:99], v[52:55], v[152:155], v[84:99]
    ds_read_b64_tr_b16 v[48:49], v22 offset:45056
    ds_read_b64_tr_b16 v[50:51], v22 offset:45568
    s_waitcnt lgkmcnt(11)
    v_mfma_f32_32x32x16_bf16 v[100:115], v[56:59], v[152:155], v[100:115]
    s_waitcnt vmcnt(0)
    s_barrier
    ds_read_b128 v[144:147], v27 offset:32768
    ds_read_b64_tr_b16 v[52:53], v19 offset:49152
    ds_read_b64_tr_b16 v[54:55], v19 offset:49664
    s_waitcnt lgkmcnt(12)
    v_mfma_f32_32x32x16_bf16 v[116:131], v[60:63], v[152:155], v[116:131]
    ds_read_b64_tr_b16 v[56:57], v20 offset:49152
    ds_read_b64_tr_b16 v[58:59], v20 offset:49664
    s_waitcnt lgkmcnt(11)
    v_mfma_f32_32x32x16_bf16 v[68:83], v[36:39], v[156:159], v[68:83]
    ds_read_b64_tr_b16 v[60:61], v21 offset:49152
    ds_read_b64_tr_b16 v[62:63], v21 offset:49664
    s_waitcnt lgkmcnt(11)
    v_mfma_f32_32x32x16_bf16 v[84:99], v[40:43], v[156:159], v[84:99]
    ds_read_b64_tr_b16 v[36:37], v22 offset:49152
    ds_read_b64_tr_b16 v[38:39], v22 offset:49664
    s_waitcnt lgkmcnt(11)
    v_mfma_f32_32x32x16_bf16 v[100:115], v[44:47], v[156:159], v[100:115]
    ds_read_b128 v[148:151], v28 offset:32768
    ds_read_b64_tr_b16 v[40:41], v19 offset:53248
    ds_read_b64_tr_b16 v[42:43], v19 offset:53760
    s_waitcnt lgkmcnt(12)
    v_mfma_f32_32x32x16_bf16 v[116:131], v[48:51], v[156:159], v[116:131]
    ds_read_b64_tr_b16 v[44:45], v20 offset:53248
    ds_read_b64_tr_b16 v[46:47], v20 offset:53760
    s_waitcnt lgkmcnt(11)
    v_mfma_f32_32x32x16_bf16 v[68:83], v[52:55], v[144:147], v[68:83]
    ds_read_b64_tr_b16 v[48:49], v21 offset:53248
    ds_read_b64_tr_b16 v[50:51], v21 offset:53760
    s_waitcnt lgkmcnt(11)
    v_mfma_f32_32x32x16_bf16 v[84:99], v[56:59], v[144:147], v[84:99]
    ds_read_b64_tr_b16 v[52:53], v22 offset:53248
    ds_read_b64_tr_b16 v[54:55], v22 offset:53760
    s_waitcnt lgkmcnt(11)
    v_mfma_f32_32x32x16_bf16 v[100:115], v[60:63], v[144:147], v[100:115]
    ds_read_b128 v[152:155], v29 offset:32768
    ds_read_b64_tr_b16 v[56:57], v19 offset:57344
    ds_read_b64_tr_b16 v[58:59], v19 offset:57856
    s_waitcnt lgkmcnt(12)
    v_mfma_f32_32x32x16_bf16 v[116:131], v[36:39], v[144:147], v[116:131]
    ds_read_b64_tr_b16 v[60:61], v20 offset:57344
    ds_read_b64_tr_b16 v[62:63], v20 offset:57856
    s_waitcnt lgkmcnt(11)
    v_mfma_f32_32x32x16_bf16 v[68:83], v[40:43], v[148:151], v[68:83]
    ds_read_b64_tr_b16 v[36:37], v21 offset:57344
    ds_read_b64_tr_b16 v[38:39], v21 offset:57856
    s_waitcnt lgkmcnt(11)
    v_mfma_f32_32x32x16_bf16 v[84:99], v[44:47], v[148:151], v[84:99]
    ds_read_b64_tr_b16 v[40:41], v22 offset:57344
    ds_read_b64_tr_b16 v[42:43], v22 offset:57856
    s_waitcnt lgkmcnt(11)
    v_mfma_f32_32x32x16_bf16 v[100:115], v[48:51], v[148:151], v[100:115]
    ds_read_b128 v[156:159], v30 offset:32768
    ds_read_b64_tr_b16 v[44:45], v19 offset:61440
    ds_read_b64_tr_b16 v[46:47], v19 offset:61952
    s_waitcnt lgkmcnt(12)
    v_mfma_f32_32x32x16_bf16 v[116:131], v[52:55], v[148:151], v[116:131]
    ds_read_b64_tr_b16 v[48:49], v20 offset:61440
    ds_read_b64_tr_b16 v[50:51], v20 offset:61952
    s_waitcnt lgkmcnt(11)
    v_mfma_f32_32x32x16_bf16 v[68:83], v[56:59], v[152:155], v[68:83]
    ds_read_b64_tr_b16 v[52:53], v21 offset:61440
    ds_read_b64_tr_b16 v[54:55], v21 offset:61952
    s_waitcnt lgkmcnt(11)
    v_mfma_f32_32x32x16_bf16 v[84:99], v[60:63], v[152:155], v[84:99]
    ds_read_b64_tr_b16 v[56:57], v22 offset:61440
    ds_read_b64_tr_b16 v[58:59], v22 offset:61952
    s_waitcnt lgkmcnt(11)
    v_mfma_f32_32x32x16_bf16 v[100:115], v[36:39], v[152:155], v[100:115]
    s_barrier
    ds_read_b128 v[144:147], v27 offset:49152
    ds_read_b64_tr_b16 v[60:61], v23 offset:0
    ds_read_b64_tr_b16 v[62:63], v23 offset:512
    s_waitcnt lgkmcnt(12)
    v_mfma_f32_32x32x16_bf16 v[116:131], v[40:43], v[152:155], v[116:131]
    ds_read_b64_tr_b16 v[36:37], v24 offset:0
    ds_read_b64_tr_b16 v[38:39], v24 offset:512
    s_waitcnt lgkmcnt(11)
    v_mfma_f32_32x32x16_bf16 v[68:83], v[44:47], v[156:159], v[68:83]
    ds_read_b64_tr_b16 v[40:41], v25 offset:0
    ds_read_b64_tr_b16 v[42:43], v25 offset:512
    s_waitcnt lgkmcnt(11)
    v_mfma_f32_32x32x16_bf16 v[84:99], v[48:51], v[156:159], v[84:99]
    ds_read_b64_tr_b16 v[44:45], v26 offset:0
    ds_read_b64_tr_b16 v[46:47], v26 offset:512
    s_waitcnt lgkmcnt(11)
    v_mfma_f32_32x32x16_bf16 v[100:115], v[52:55], v[156:159], v[100:115]
    ds_read_b128 v[148:151], v28 offset:49152
    ds_read_b64_tr_b16 v[48:49], v23 offset:4096
    ds_read_b64_tr_b16 v[50:51], v23 offset:4608
    s_waitcnt lgkmcnt(12)
    v_mfma_f32_32x32x16_bf16 v[116:131], v[56:59], v[156:159], v[116:131]
    ds_read_b64_tr_b16 v[52:53], v24 offset:4096
    ds_read_b64_tr_b16 v[54:55], v24 offset:4608
    s_waitcnt lgkmcnt(11)
    v_mfma_f32_32x32x16_bf16 v[68:83], v[60:63], v[144:147], v[68:83]
    ds_read_b64_tr_b16 v[56:57], v25 offset:4096
    ds_read_b64_tr_b16 v[58:59], v25 offset:4608
    s_waitcnt lgkmcnt(11)
    v_mfma_f32_32x32x16_bf16 v[84:99], v[36:39], v[144:147], v[84:99]
    ds_read_b64_tr_b16 v[60:61], v26 offset:4096
    ds_read_b64_tr_b16 v[62:63], v26 offset:4608
    s_waitcnt lgkmcnt(11)
    v_mfma_f32_32x32x16_bf16 v[100:115], v[40:43], v[144:147], v[100:115]
    ds_read_b128 v[152:155], v29 offset:49152
    ds_read_b64_tr_b16 v[36:37], v23 offset:8192
    ds_read_b64_tr_b16 v[38:39], v23 offset:8704
    s_waitcnt lgkmcnt(12)
    v_mfma_f32_32x32x16_bf16 v[116:131], v[44:47], v[144:147], v[116:131]
    ds_read_b64_tr_b16 v[40:41], v24 offset:8192
    ds_read_b64_tr_b16 v[42:43], v24 offset:8704
    s_waitcnt lgkmcnt(11)
    v_mfma_f32_32x32x16_bf16 v[68:83], v[48:51], v[148:151], v[68:83]
    ds_read_b64_tr_b16 v[44:45], v25 offset:8192
    ds_read_b64_tr_b16 v[46:47], v25 offset:8704
    s_waitcnt lgkmcnt(11)
    v_mfma_f32_32x32x16_bf16 v[84:99], v[52:55], v[148:151], v[84:99]
    ds_read_b64_tr_b16 v[48:49], v26 offset:8192
    ds_read_b64_tr_b16 v[50:51], v26 offset:8704
    s_waitcnt lgkmcnt(11)
    v_mfma_f32_32x32x16_bf16 v[100:115], v[56:59], v[148:151], v[100:115]
    ds_read_b128 v[156:159], v30 offset:49152
    ds_read_b64_tr_b16 v[52:53], v23 offset:12288
    ds_read_b64_tr_b16 v[54:55], v23 offset:12800
    s_waitcnt lgkmcnt(12)
    v_mfma_f32_32x32x16_bf16 v[116:131], v[60:63], v[148:151], v[116:131]
    ds_read_b64_tr_b16 v[56:57], v24 offset:12288
    ds_read_b64_tr_b16 v[58:59], v24 offset:12800
    s_waitcnt lgkmcnt(11)
    v_mfma_f32_32x32x16_bf16 v[68:83], v[36:39], v[152:155], v[68:83]
    ds_read_b64_tr_b16 v[60:61], v25 offset:12288
    ds_read_b64_tr_b16 v[62:63], v25 offset:12800
    s_waitcnt lgkmcnt(11)
    v_mfma_f32_32x32x16_bf16 v[84:99], v[40:43], v[152:155], v[84:99]
    ds_read_b64_tr_b16 v[36:37], v26 offset:12288
    ds_read_b64_tr_b16 v[38:39], v26 offset:12800
    s_waitcnt lgkmcnt(11)
    v_mfma_f32_32x32x16_bf16 v[100:115], v[44:47], v[152:155], v[100:115]
    s_barrier
    ds_read_b128 v[144:147], v31 offset:0
    ds_read_b64_tr_b16 v[40:41], v23 offset:16384
    ds_read_b64_tr_b16 v[42:43], v23 offset:16896
    s_waitcnt lgkmcnt(12)
    v_mfma_f32_32x32x16_bf16 v[116:131], v[48:51], v[152:155], v[116:131]
    ds_read_b64_tr_b16 v[44:45], v24 offset:16384
    ds_read_b64_tr_b16 v[46:47], v24 offset:16896
    s_waitcnt lgkmcnt(11)
    v_mfma_f32_32x32x16_bf16 v[68:83], v[52:55], v[156:159], v[68:83]
    ds_read_b64_tr_b16 v[48:49], v25 offset:16384
    ds_read_b64_tr_b16 v[50:51], v25 offset:16896
    s_waitcnt lgkmcnt(11)
    v_mfma_f32_32x32x16_bf16 v[84:99], v[56:59], v[156:159], v[84:99]
    ds_read_b64_tr_b16 v[52:53], v26 offset:16384
    ds_read_b64_tr_b16 v[54:55], v26 offset:16896
    s_waitcnt lgkmcnt(11)
    v_mfma_f32_32x32x16_bf16 v[100:115], v[60:63], v[156:159], v[100:115]
    ds_read_b128 v[148:151], v32 offset:0
    ds_read_b64_tr_b16 v[56:57], v23 offset:20480
    ds_read_b64_tr_b16 v[58:59], v23 offset:20992
    s_waitcnt lgkmcnt(12)
    v_mfma_f32_32x32x16_bf16 v[116:131], v[36:39], v[156:159], v[116:131]
    ds_read_b64_tr_b16 v[60:61], v24 offset:20480
    ds_read_b64_tr_b16 v[62:63], v24 offset:20992
    s_waitcnt lgkmcnt(11)
    v_mfma_f32_32x32x16_bf16 v[68:83], v[40:43], v[144:147], v[68:83]
    ds_read_b64_tr_b16 v[36:37], v25 offset:20480
    ds_read_b64_tr_b16 v[38:39], v25 offset:20992
    s_waitcnt lgkmcnt(11)
    v_mfma_f32_32x32x16_bf16 v[84:99], v[44:47], v[144:147], v[84:99]
    ds_read_b64_tr_b16 v[40:41], v26 offset:20480
    ds_read_b64_tr_b16 v[42:43], v26 offset:20992
    s_waitcnt lgkmcnt(11)
    v_mfma_f32_32x32x16_bf16 v[100:115], v[48:51], v[144:147], v[100:115]
    ds_read_b128 v[152:155], v33 offset:0
    ds_read_b64_tr_b16 v[44:45], v23 offset:24576
    ds_read_b64_tr_b16 v[46:47], v23 offset:25088
    s_waitcnt lgkmcnt(12)
    v_mfma_f32_32x32x16_bf16 v[116:131], v[52:55], v[144:147], v[116:131]
    ds_read_b64_tr_b16 v[48:49], v24 offset:24576
    ds_read_b64_tr_b16 v[50:51], v24 offset:25088
    s_waitcnt lgkmcnt(11)
    v_mfma_f32_32x32x16_bf16 v[68:83], v[56:59], v[148:151], v[68:83]
    ds_read_b64_tr_b16 v[52:53], v25 offset:24576
    ds_read_b64_tr_b16 v[54:55], v25 offset:25088
    s_waitcnt lgkmcnt(11)
    v_mfma_f32_32x32x16_bf16 v[84:99], v[60:63], v[148:151], v[84:99]
    ds_read_b64_tr_b16 v[56:57], v26 offset:24576
    ds_read_b64_tr_b16 v[58:59], v26 offset:25088
    s_waitcnt lgkmcnt(11)
    v_mfma_f32_32x32x16_bf16 v[100:115], v[36:39], v[148:151], v[100:115]
    ds_read_b128 v[156:159], v34 offset:0
    ds_read_b64_tr_b16 v[60:61], v23 offset:28672
    ds_read_b64_tr_b16 v[62:63], v23 offset:29184
    s_waitcnt lgkmcnt(12)
    v_mfma_f32_32x32x16_bf16 v[116:131], v[40:43], v[148:151], v[116:131]
    ds_read_b64_tr_b16 v[36:37], v24 offset:28672
    ds_read_b64_tr_b16 v[38:39], v24 offset:29184
    s_waitcnt lgkmcnt(11)
    v_mfma_f32_32x32x16_bf16 v[68:83], v[44:47], v[152:155], v[68:83]
    ds_read_b64_tr_b16 v[40:41], v25 offset:28672
    ds_read_b64_tr_b16 v[42:43], v25 offset:29184
    s_waitcnt lgkmcnt(11)
    v_mfma_f32_32x32x16_bf16 v[84:99], v[48:51], v[152:155], v[84:99]
    ds_read_b64_tr_b16 v[44:45], v26 offset:28672
    ds_read_b64_tr_b16 v[46:47], v26 offset:29184
    s_waitcnt lgkmcnt(11)
    v_mfma_f32_32x32x16_bf16 v[100:115], v[52:55], v[152:155], v[100:115]
    s_barrier
    ds_read_b128 v[144:147], v27 offset:0
    ds_read_b64_tr_b16 v[48:49], v19 offset:16384
    ds_read_b64_tr_b16 v[50:51], v19 offset:16896
    s_waitcnt lgkmcnt(12)
    v_mfma_f32_32x32x16_bf16 v[116:131], v[56:59], v[152:155], v[116:131]
    ds_read_b64_tr_b16 v[52:53], v20 offset:16384
    ds_read_b64_tr_b16 v[54:55], v20 offset:16896
    s_waitcnt lgkmcnt(11)
    v_mfma_f32_32x32x16_bf16 v[68:83], v[60:63], v[156:159], v[68:83]
    ds_read_b64_tr_b16 v[56:57], v21 offset:16384
    ds_read_b64_tr_b16 v[58:59], v21 offset:16896
    s_waitcnt lgkmcnt(11)
    v_mfma_f32_32x32x16_bf16 v[84:99], v[36:39], v[156:159], v[84:99]
    ds_read_b64_tr_b16 v[60:61], v22 offset:16384
    ds_read_b64_tr_b16 v[62:63], v22 offset:16896
    s_waitcnt lgkmcnt(11)
    v_mfma_f32_32x32x16_bf16 v[100:115], v[40:43], v[156:159], v[100:115]
    ds_read_b128 v[148:151], v28 offset:0
    ds_read_b64_tr_b16 v[36:37], v19 offset:20480
    ds_read_b64_tr_b16 v[38:39], v19 offset:20992
    s_waitcnt lgkmcnt(12)
    v_mfma_f32_32x32x16_bf16 v[116:131], v[44:47], v[156:159], v[116:131]
    ds_read_b64_tr_b16 v[40:41], v20 offset:20480
    ds_read_b64_tr_b16 v[42:43], v20 offset:20992
    s_waitcnt lgkmcnt(11)
    v_mfma_f32_32x32x16_bf16 v[68:83], v[48:51], v[144:147], v[68:83]
    ds_read_b64_tr_b16 v[44:45], v21 offset:20480
    ds_read_b64_tr_b16 v[46:47], v21 offset:20992
    s_waitcnt lgkmcnt(11)
    v_mfma_f32_32x32x16_bf16 v[84:99], v[52:55], v[144:147], v[84:99]
    ds_read_b64_tr_b16 v[48:49], v22 offset:20480
    ds_read_b64_tr_b16 v[50:51], v22 offset:20992
    s_waitcnt lgkmcnt(11)
    v_mfma_f32_32x32x16_bf16 v[100:115], v[56:59], v[144:147], v[100:115]
    ds_read_b128 v[152:155], v29 offset:0
    ds_read_b64_tr_b16 v[52:53], v19 offset:24576
    ds_read_b64_tr_b16 v[54:55], v19 offset:25088
    s_waitcnt lgkmcnt(12)
    v_mfma_f32_32x32x16_bf16 v[116:131], v[60:63], v[144:147], v[116:131]
    ds_read_b64_tr_b16 v[56:57], v20 offset:24576
    ds_read_b64_tr_b16 v[58:59], v20 offset:25088
    s_waitcnt lgkmcnt(11)
    v_mfma_f32_32x32x16_bf16 v[68:83], v[36:39], v[148:151], v[68:83]
    ds_read_b64_tr_b16 v[60:61], v21 offset:24576
    ds_read_b64_tr_b16 v[62:63], v21 offset:25088
    s_waitcnt lgkmcnt(11)
    v_mfma_f32_32x32x16_bf16 v[84:99], v[40:43], v[148:151], v[84:99]
    ds_read_b64_tr_b16 v[36:37], v22 offset:24576
    ds_read_b64_tr_b16 v[38:39], v22 offset:25088
    s_waitcnt lgkmcnt(11)
    v_mfma_f32_32x32x16_bf16 v[100:115], v[44:47], v[148:151], v[100:115]
    ds_read_b128 v[156:159], v30 offset:0
    ds_read_b64_tr_b16 v[40:41], v19 offset:28672
    ds_read_b64_tr_b16 v[42:43], v19 offset:29184
    s_waitcnt lgkmcnt(12)
    v_mfma_f32_32x32x16_bf16 v[116:131], v[48:51], v[148:151], v[116:131]
    ds_read_b64_tr_b16 v[44:45], v20 offset:28672
    ds_read_b64_tr_b16 v[46:47], v20 offset:29184
    s_waitcnt lgkmcnt(11)
    v_mfma_f32_32x32x16_bf16 v[68:83], v[52:55], v[152:155], v[68:83]
    ds_read_b64_tr_b16 v[48:49], v21 offset:28672
    ds_read_b64_tr_b16 v[50:51], v21 offset:29184
    s_waitcnt lgkmcnt(11)
    v_mfma_f32_32x32x16_bf16 v[84:99], v[56:59], v[152:155], v[84:99]
    ds_read_b64_tr_b16 v[52:53], v22 offset:28672
    ds_read_b64_tr_b16 v[54:55], v22 offset:29184
    s_waitcnt lgkmcnt(11)
    v_mfma_f32_32x32x16_bf16 v[100:115], v[60:63], v[152:155], v[100:115]
    s_barrier
    ds_read_b128 v[144:147], v27 offset:16384
    ds_read_b64_tr_b16 v[56:57], v19 offset:32768
    ds_read_b64_tr_b16 v[58:59], v19 offset:33280
    s_waitcnt lgkmcnt(12)
    v_mfma_f32_32x32x16_bf16 v[116:131], v[36:39], v[152:155], v[116:131]
    ds_read_b64_tr_b16 v[60:61], v20 offset:32768
    ds_read_b64_tr_b16 v[62:63], v20 offset:33280
    s_waitcnt lgkmcnt(11)
    v_mfma_f32_32x32x16_bf16 v[68:83], v[40:43], v[156:159], v[68:83]
    ds_read_b64_tr_b16 v[36:37], v21 offset:32768
    ds_read_b64_tr_b16 v[38:39], v21 offset:33280
    s_waitcnt lgkmcnt(11)
    v_mfma_f32_32x32x16_bf16 v[84:99], v[44:47], v[156:159], v[84:99]
    ds_read_b64_tr_b16 v[40:41], v22 offset:32768
    ds_read_b64_tr_b16 v[42:43], v22 offset:33280
    s_waitcnt lgkmcnt(11)
    v_mfma_f32_32x32x16_bf16 v[100:115], v[48:51], v[156:159], v[100:115]
    ds_read_b128 v[148:151], v28 offset:16384
    ds_read_b64_tr_b16 v[44:45], v19 offset:36864
    ds_read_b64_tr_b16 v[46:47], v19 offset:37376
    s_waitcnt lgkmcnt(12)
    v_mfma_f32_32x32x16_bf16 v[116:131], v[52:55], v[156:159], v[116:131]
    ds_read_b64_tr_b16 v[48:49], v20 offset:36864
    ds_read_b64_tr_b16 v[50:51], v20 offset:37376
    s_waitcnt lgkmcnt(11)
    v_mfma_f32_32x32x16_bf16 v[68:83], v[56:59], v[144:147], v[68:83]
    ds_read_b64_tr_b16 v[52:53], v21 offset:36864
    ds_read_b64_tr_b16 v[54:55], v21 offset:37376
    s_waitcnt lgkmcnt(11)
    v_mfma_f32_32x32x16_bf16 v[84:99], v[60:63], v[144:147], v[84:99]
    ds_read_b64_tr_b16 v[56:57], v22 offset:36864
    ds_read_b64_tr_b16 v[58:59], v22 offset:37376
    s_waitcnt lgkmcnt(11)
    v_mfma_f32_32x32x16_bf16 v[100:115], v[36:39], v[144:147], v[100:115]
    ds_read_b128 v[152:155], v29 offset:16384
    ds_read_b64_tr_b16 v[60:61], v19 offset:40960
    ds_read_b64_tr_b16 v[62:63], v19 offset:41472
    s_waitcnt lgkmcnt(12)
    v_mfma_f32_32x32x16_bf16 v[116:131], v[40:43], v[144:147], v[116:131]
    ds_read_b64_tr_b16 v[36:37], v20 offset:40960
    ds_read_b64_tr_b16 v[38:39], v20 offset:41472
    s_waitcnt lgkmcnt(11)
    v_mfma_f32_32x32x16_bf16 v[68:83], v[44:47], v[148:151], v[68:83]
    ds_read_b64_tr_b16 v[40:41], v21 offset:40960
    ds_read_b64_tr_b16 v[42:43], v21 offset:41472
    s_waitcnt lgkmcnt(11)
    v_mfma_f32_32x32x16_bf16 v[84:99], v[48:51], v[148:151], v[84:99]
    ds_read_b64_tr_b16 v[44:45], v22 offset:40960
    ds_read_b64_tr_b16 v[46:47], v22 offset:41472
    s_waitcnt lgkmcnt(11)
    v_mfma_f32_32x32x16_bf16 v[100:115], v[52:55], v[148:151], v[100:115]
    ds_read_b128 v[156:159], v30 offset:16384
    ds_read_b64_tr_b16 v[48:49], v19 offset:45056
    ds_read_b64_tr_b16 v[50:51], v19 offset:45568
    s_waitcnt lgkmcnt(12)
    v_mfma_f32_32x32x16_bf16 v[116:131], v[56:59], v[148:151], v[116:131]
    ds_read_b64_tr_b16 v[52:53], v20 offset:45056
    ds_read_b64_tr_b16 v[54:55], v20 offset:45568
    s_waitcnt lgkmcnt(11)
    v_mfma_f32_32x32x16_bf16 v[68:83], v[60:63], v[152:155], v[68:83]
    ds_read_b64_tr_b16 v[56:57], v21 offset:45056
    ds_read_b64_tr_b16 v[58:59], v21 offset:45568
    s_waitcnt lgkmcnt(11)
    v_mfma_f32_32x32x16_bf16 v[84:99], v[36:39], v[152:155], v[84:99]
    ds_read_b64_tr_b16 v[60:61], v22 offset:45056
    ds_read_b64_tr_b16 v[62:63], v22 offset:45568
    s_waitcnt lgkmcnt(11)
    v_mfma_f32_32x32x16_bf16 v[100:115], v[40:43], v[152:155], v[100:115]
    s_barrier
    s_waitcnt lgkmcnt(9)
    v_mfma_f32_32x32x16_bf16 v[116:131], v[44:47], v[152:155], v[116:131]
    s_waitcnt lgkmcnt(6)
    v_mfma_f32_32x32x16_bf16 v[68:83], v[48:51], v[156:159], v[68:83]
    s_waitcnt lgkmcnt(4)
    v_mfma_f32_32x32x16_bf16 v[84:99], v[52:55], v[156:159], v[84:99]
    s_waitcnt lgkmcnt(2)
    v_mfma_f32_32x32x16_bf16 v[100:115], v[56:59], v[156:159], v[100:115]
    s_waitcnt lgkmcnt(0)
    v_mfma_f32_32x32x16_bf16 v[116:131], v[60:63], v[156:159], v[116:131]
    v_mov_b32 v14, 0
    global_load_dword v13, v14, s[14:15] sc1
    v_mov_b32 v15, v35
    v_xor_b32 v16, 64, v35
    v_add_u32 v17, 0x10000, v35
    v_xor_b32 v18, 64, v17
    v_add_u32 v19, 0x20000, v35
    v_xor_b32 v20, 64, v19
    s_add_u32 m0, s52, 0
    s_mul_i32 s58, s10, 229376
    s_add_u32 s58, s58, s51
    s_add_u32 s58, s58, 128
    buffer_load_dwordx4 v3, s[24:27], s58 offen lds
    buffer_load_dwordx4 v4, s[24:27], s58 offen offset:2048 lds
    s_nop 7
    v_mul_f32 v48, v116, v116
    v_mul_f32 v49, v117, v117
    v_mul_f32 v50, v118, v118
    v_mul_f32 v51, v119, v119
    v_fma_f32 v48, v48, v10, s54
    v_fma_f32 v49, v49, v10, s54
    v_fma_f32 v50, v50, v10, s54
    v_fma_f32 v51, v51, v10, s54
    v_mul_f32 v48, v116, v48
    v_mul_f32 v49, v117, v49
    v_mul_f32 v50, v118, v50
    v_mul_f32 v51, v119, v51
    v_exp_f32 v48, v48
    v_exp_f32 v49, v49
    v_exp_f32 v50, v50
    v_exp_f32 v51, v51
    v_mul_f32 v116, v116, v124
    v_mul_f32 v117, v117, v125
    v_mul_f32 v118, v118, v126
    v_mul_f32 v119, v119, v127
    v_add_f32 v48, 1.0, v48
    v_add_f32 v49, 1.0, v49
    v_add_f32 v50, 1.0, v50
    v_add_f32 v51, 1.0, v51
    s_add_u32 m0, s52, 1024
    s_mul_i32 s58, s10, 229376
    s_add_u32 s58, s58, s51
    s_add_u32 s58, s58, 128
    buffer_load_dwordx4 v5, s[28:31], s58 offen lds
    v_rcp_f32 v48, v48
    v_rcp_f32 v49, v49
    v_rcp_f32 v50, v50
    v_rcp_f32 v51, v51
    v_mul_f32 v48, v116, v48
    v_mul_f32 v49, v117, v49
    v_mul_f32 v50, v118, v50
    v_mul_f32 v51, v119, v51
    v_cvt_pk_bf16_f32 v56, v48, v49
    v_cvt_pk_bf16_f32 v57, v50, v51
    v_mul_f32 v52, v120, v120
    v_mul_f32 v53, v121, v121
    v_mul_f32 v54, v122, v122
    v_mul_f32 v55, v123, v123
    v_fma_f32 v52, v52, v10, s54
    v_fma_f32 v53, v53, v10, s54
    v_fma_f32 v54, v54, v10, s54
    v_fma_f32 v55, v55, v10, s54
    v_mul_f32 v52, v120, v52
    v_mul_f32 v53, v121, v53
    v_mul_f32 v54, v122, v54
    v_mul_f32 v55, v123, v55
    v_exp_f32 v52, v52
    v_exp_f32 v53, v53
    buffer_load_dwordx4 v6, s[28:31], s58 offen offset:2048 lds
    v_exp_f32 v54, v54
    v_exp_f32 v55, v55
    v_mul_f32 v120, v120, v128
    v_mul_f32 v121, v121, v129
    v_mul_f32 v122, v122, v130
    v_mul_f32 v123, v123, v131
    v_add_f32 v52, 1.0, v52
    v_add_f32 v53, 1.0, v53
    v_add_f32 v54, 1.0, v54
    v_add_f32 v55, 1.0, v55
    v_rcp_f32 v52, v52
    v_rcp_f32 v53, v53
    v_rcp_f32 v54, v54
    v_rcp_f32 v55, v55
    v_mul_f32 v52, v120, v52
    v_mul_f32 v53, v121, v53
    v_mul_f32 v54, v122, v54
    v_mul_f32 v55, v123, v55
    v_cvt_pk_bf16_f32 v58, v52, v53
    v_cvt_pk_bf16_f32 v59, v54, v55
    s_add_u32 s57, s53, 3072
    buffer_store_dwordx4 v[56:59], v9, s[32:35], s57 offen sc1
    v_mul_f32 v36, v100, v100
    v_mul_f32 v37, v101, v101
    v_mul_f32 v38, v102, v102
    s_barrier
    v_mul_f32 v39, v103, v103
    v_fma_f32 v36, v36, v10, s54
    v_fma_f32 v37, v37, v10, s54
    v_fma_f32 v38, v38, v10, s54
    v_fma_f32 v39, v39, v10, s54
    v_mul_f32 v36, v100, v36
    v_mul_f32 v37, v101, v37
    v_mul_f32 v38, v102, v38
    v_mul_f32 v39, v103, v39
    v_exp_f32 v36, v36
    v_exp_f32 v37, v37
    v_exp_f32 v38, v38
    v_exp_f32 v39, v39
    v_mul_f32 v100, v100, v108
    s_add_u32 m0, s52, 81920
    s_mul_i32 s58, s64, 229376
    s_add_u32 s58, s58, s59
    buffer_load_dwordx4 v7, s[36:39], s58 offen lds
    v_mul_f32 v101, v101, v109
    v_mul_f32 v102, v102, v110
    v_mul_f32 v103, v103, v111
    v_add_f32 v36, 1.0, v36
    v_add_f32 v37, 1.0, v37
    v_add_f32 v38, 1.0, v38
    v_add_f32 v39, 1.0, v39
    v_rcp_f32 v36, v36
    v_rcp_f32 v37, v37
    v_rcp_f32 v38, v38
    v_rcp_f32 v39, v39
    v_mul_f32 v36, v100, v36
    v_mul_f32 v37, v101, v37
    v_mul_f32 v38, v102, v38
    buffer_load_dwordx4 v8, s[36:39], s58 offen offset:1024 lds
    v_mul_f32 v39, v103, v39
    v_cvt_pk_bf16_f32 v44, v36, v37
    v_cvt_pk_bf16_f32 v45, v38, v39
    v_mul_f32 v40, v104, v104
    v_mul_f32 v41, v105, v105
    v_mul_f32 v42, v106, v106
    v_mul_f32 v43, v107, v107
    v_fma_f32 v40, v40, v10, s54
    v_fma_f32 v41, v41, v10, s54
    v_fma_f32 v42, v42, v10, s54
    v_fma_f32 v43, v43, v10, s54
    v_mul_f32 v40, v104, v40
    v_mul_f32 v41, v105, v41
    v_mul_f32 v42, v106, v42
    s_add_u32 m0, s52, 83968
    s_mul_i32 s58, s64, 229376
    s_add_u32 s58, s58, s59
    s_add_u32 s58, s58, 14336
    buffer_load_dwordx4 v7, s[36:39], s58 offen lds
    v_mul_f32 v43, v107, v43
    v_exp_f32 v40, v40
    v_exp_f32 v41, v41
    v_exp_f32 v42, v42
    v_exp_f32 v43, v43
    v_mul_f32 v104, v104, v112
    v_mul_f32 v105, v105, v113
    v_mul_f32 v106, v106, v114
    v_mul_f32 v107, v107, v115
    v_add_f32 v40, 1.0, v40
    v_add_f32 v41, 1.0, v41
    v_add_f32 v42, 1.0, v42
    v_add_f32 v43, 1.0, v43
    v_rcp_f32 v40, v40
    buffer_load_dwordx4 v8, s[36:39], s58 offen offset:1024 lds
    v_rcp_f32 v41, v41
    v_rcp_f32 v42, v42
    v_rcp_f32 v43, v43
    v_mul_f32 v40, v104, v40
    v_mul_f32 v41, v105, v41
    v_mul_f32 v42, v106, v42
    v_mul_f32 v43, v107, v43
    v_cvt_pk_bf16_f32 v46, v40, v41
    v_cvt_pk_bf16_f32 v47, v42, v43
    s_add_u32 s57, s53, 2048
    buffer_store_dwordx4 v[44:47], v9, s[32:35], s57 offen sc1
    v_mul_f32 v48, v84, v84
    v_mul_f32 v49, v85, v85
    v_mul_f32 v50, v86, v86
    v_mul_f32 v51, v87, v87
    v_fma_f32 v48, v48, v10, s54
    v_fma_f32 v49, v49, v10, s54
    s_barrier
    v_fma_f32 v50, v50, v10, s54
    v_fma_f32 v51, v51, v10, s54
    v_mul_f32 v48, v84, v48
    v_mul_f32 v49, v85, v49
    v_mul_f32 v50, v86, v50
    v_mul_f32 v51, v87, v51
    v_exp_f32 v48, v48
    v_exp_f32 v49, v49
    v_exp_f32 v50, v50
    v_exp_f32 v51, v51
    v_mul_f32 v84, v84, v92
    v_mul_f32 v85, v85, v93
    v_mul_f32 v86, v86, v94
    v_mul_f32 v87, v87, v95
    s_add_u32 m0, s52, 16384
    s_mul_i32 s58, s65, 229376
    s_add_u32 s58, s58, s59
    buffer_load_dwordx4 v7, s[36:39], s58 offen lds
    v_add_f32 v48, 1.0, v48
    v_add_f32 v49, 1.0, v49
    v_add_f32 v50, 1.0, v50
    v_add_f32 v51, 1.0, v51
    v_rcp_f32 v48, v48
    v_rcp_f32 v49, v49
    v_rcp_f32 v50, v50
    v_rcp_f32 v51, v51
    v_mul_f32 v48, v84, v48
    v_mul_f32 v49, v85, v49
    v_mul_f32 v50, v86, v50
    v_mul_f32 v51, v87, v51
    v_cvt_pk_bf16_f32 v56, v48, v49
    v_cvt_pk_bf16_f32 v57, v50, v51
    buffer_load_dwordx4 v8, s[36:39], s58 offen offset:1024 lds
    v_mul_f32 v52, v88, v88
    v_mul_f32 v53, v89, v89
    v_mul_f32 v54, v90, v90
    v_mul_f32 v55, v91, v91
    v_fma_f32 v52, v52, v10, s54
    v_fma_f32 v53, v53, v10, s54
    v_fma_f32 v54, v54, v10, s54
    v_fma_f32 v55, v55, v10, s54
    v_mul_f32 v52, v88, v52
    v_mul_f32 v53, v89, v53
    v_mul_f32 v54, v90, v54
    v_mul_f32 v55, v91, v55
    v_exp_f32 v52, v52
    v_exp_f32 v53, v53
    s_add_u32 m0, s52, 18432
    s_mul_i32 s58, s65, 229376
    s_add_u32 s58, s58, s59
    s_add_u32 s58, s58, 14336
    buffer_load_dwordx4 v7, s[36:39], s58 offen lds
    v_exp_f32 v54, v54
    v_exp_f32 v55, v55
    v_mul_f32 v88, v88, v96
    v_mul_f32 v89, v89, v97
    v_mul_f32 v90, v90, v98
    v_mul_f32 v91, v91, v99
    v_add_f32 v52, 1.0, v52
    v_add_f32 v53, 1.0, v53
    v_add_f32 v54, 1.0, v54
    v_add_f32 v55, 1.0, v55
    v_rcp_f32 v52, v52
    v_rcp_f32 v53, v53
    v_rcp_f32 v54, v54
    v_rcp_f32 v55, v55
    buffer_load_dwordx4 v8, s[36:39], s58 offen offset:1024 lds
    v_mul_f32 v52, v88, v52
    v_mul_f32 v53, v89, v53
    v_mul_f32 v54, v90, v54
    v_mul_f32 v55, v91, v55
    v_cvt_pk_bf16_f32 v58, v52, v53
    v_cvt_pk_bf16_f32 v59, v54, v55
    s_add_u32 s57, s53, 1024
    buffer_store_dwordx4 v[56:59], v9, s[32:35], s57 offen sc1
    v_mul_f32 v36, v68, v68
    v_mul_f32 v37, v69, v69
    v_mul_f32 v38, v70, v70
    v_mul_f32 v39, v71, v71
    v_fma_f32 v36, v36, v10, s54
    v_fma_f32 v37, v37, v10, s54
    v_fma_f32 v38, v38, v10, s54
    v_fma_f32 v39, v39, v10, s54
    v_mul_f32 v36, v68, v36
    s_barrier
    v_mul_f32 v37, v69, v37
    v_mul_f32 v38, v70, v38
    v_mul_f32 v39, v71, v39
    v_exp_f32 v36, v36
    v_exp_f32 v37, v37
    v_exp_f32 v38, v38
    v_exp_f32 v39, v39
    v_mul_f32 v68, v68, v76
    v_mul_f32 v69, v69, v77
    v_mul_f32 v70, v70, v78
    v_mul_f32 v71, v71, v79
    v_add_f32 v36, 1.0, v36
    s_add_u32 m0, s52, 98304
    s_mul_i32 s58, s66, 229376
    s_add_u32 s58, s58, s59
    buffer_load_dwordx4 v7, s[36:39], s58 offen lds
    v_add_f32 v37, 1.0, v37
    v_add_f32 v38, 1.0, v38
    v_add_f32 v39, 1.0, v39
    v_rcp_f32 v36, v36
    v_rcp_f32 v37, v37
    v_rcp_f32 v38, v38
    v_rcp_f32 v39, v39
    v_mul_f32 v36, v68, v36
    v_mul_f32 v37, v69, v37
    v_mul_f32 v38, v70, v38
    v_mul_f32 v39, v71, v39
    v_cvt_pk_bf16_f32 v44, v36, v37
    buffer_load_dwordx4 v8, s[36:39], s58 offen offset:1024 lds
    v_cvt_pk_bf16_f32 v45, v38, v39
    v_mul_f32 v40, v72, v72
    v_mul_f32 v41, v73, v73
    v_mul_f32 v42, v74, v74
    v_mul_f32 v43, v75, v75
    v_fma_f32 v40, v40, v10, s54
    v_fma_f32 v41, v41, v10, s54
    v_fma_f32 v42, v42, v10, s54
    v_fma_f32 v43, v43, v10, s54
    v_mul_f32 v40, v72, v40
    v_mul_f32 v41, v73, v41
    v_mul_f32 v42, v74, v42
    s_add_u32 m0, s52, 100352
    s_mul_i32 s58, s66, 229376
    s_add_u32 s58, s58, s59
    s_add_u32 s58, s58, 14336
    buffer_load_dwordx4 v7, s[36:39], s58 offen lds
    v_mul_f32 v43, v75, v43
    v_exp_f32 v40, v40
    v_exp_f32 v41, v41
    v_exp_f32 v42, v42
    v_exp_f32 v43, v43
    v_mul_f32 v72, v72, v80
    v_mul_f32 v73, v73, v81
    v_mul_f32 v74, v74, v82
    v_mul_f32 v75, v75, v83
    v_add_f32 v40, 1.0, v40
    v_add_f32 v41, 1.0, v41
    v_add_f32 v42, 1.0, v42
    buffer_load_dwordx4 v8, s[36:39], s58 offen offset:1024 lds
    v_add_f32 v43, 1.0, v43
    v_rcp_f32 v40, v40
    v_rcp_f32 v41, v41
    v_rcp_f32 v42, v42
    v_rcp_f32 v43, v43
    v_mul_f32 v40, v72, v40
    v_mul_f32 v41, v73, v41
    v_mul_f32 v42, v74, v42
    v_mul_f32 v43, v75, v43
    v_cvt_pk_bf16_f32 v46, v40, v41
    v_cvt_pk_bf16_f32 v47, v42, v43
    s_add_u32 s57, s53, 0
    buffer_store_dwordx4 v[44:47], v9, s[32:35], s57 offen sc1
    s_waitcnt vmcnt(11)
    s_barrier
    ds_read_b64_tr_b16 v[192:193], v17 offset:16384
    ds_read_b64_tr_b16 v[194:195], v17 offset:17408
    ds_read_b64_tr_b16 v[196:197], v18 offset:16384
    ds_read_b64_tr_b16 v[198:199], v18 offset:17408
    ds_read_b64_tr_b16 v[200:201], v17 offset:18432
    ds_read_b64_tr_b16 v[202:203], v17 offset:19456
    ds_read_b64_tr_b16 v[204:205], v18 offset:18432
    ds_read_b64_tr_b16 v[206:207], v18 offset:19456
    ds_read_b64_tr_b16 v[208:209], v17 offset:20480
    ds_read_b64_tr_b16 v[210:211], v17 offset:21504
    ds_read_b64_tr_b16 v[212:213], v18 offset:20480
    ds_read_b64_tr_b16 v[214:215], v18 offset:21504
    ds_read_b64_tr_b16 v[216:217], v17 offset:22528
    ds_read_b64_tr_b16 v[218:219], v17 offset:23552
    ds_read_b64_tr_b16 v[220:221], v18 offset:22528
    ds_read_b64_tr_b16 v[222:223], v18 offset:23552
    s_add_u32 m0, s52, 32768
    s_mul_i32 s58, s67, 229376
    s_add_u32 s58, s58, s59
    buffer_load_dwordx4 v7, s[36:39], s58 offen lds
    buffer_load_dwordx4 v8, s[36:39], s58 offen offset:1024 lds
    s_add_u32 m0, s52, 34816
    s_mul_i32 s58, s67, 229376
    s_add_u32 s58, s58, s59
    s_add_u32 s58, s58, 14336
    buffer_load_dwordx4 v7, s[36:39], s58 offen lds
    buffer_load_dwordx4 v8, s[36:39], s58 offen offset:1024 lds
    s_add_u32 m0, s52, 114688
    s_mul_i32 s58, s68, 229376
    s_add_u32 s58, s58, s59
    buffer_load_dwordx4 v7, s[36:39], s58 offen lds
    buffer_load_dwordx4 v8, s[36:39], s58 offen offset:1024 lds
    s_add_u32 m0, s52, 116736
    s_mul_i32 s58, s68, 229376
    s_add_u32 s58, s58, s59
    s_add_u32 s58, s58, 14336
    buffer_load_dwordx4 v7, s[36:39], s58 offen lds
    buffer_load_dwordx4 v8, s[36:39], s58 offen offset:1024 lds
    v_readfirstlane_b32 s61, v13
    s_cmp_lg_u32 s61, 0
    s_cbranch_scc1 L_nok_1
L_nlp_2:
    s_sleep 2
    global_load_dword v13, v14, s[14:15] sc1
    s_waitcnt vmcnt(0)
    v_readfirstlane_b32 s61, v13
    s_cmp_eq_u32 s61, 0
    s_cbranch_scc1 L_nlp_2
L_nok_1:
    v_mov_b32 v14, s61
    s_waitcnt vmcnt(8)
    s_mov_b64 exec, 1
    global_store_dword v11, v14, s[16:17] offset:0 sc0 sc1
    s_mov_b64 exec, -1
    s_barrier
    ds_read_b64_tr_b16 v[224:225], v15 offset:16384
    ds_read_b64_tr_b16 v[226:227], v15 offset:17408
    ds_read_b64_tr_b16 v[228:229], v16 offset:16384
    ds_read_b64_tr_b16 v[230:231], v16 offset:17408
    ds_read_b64_tr_b16 v[232:233], v15 offset:18432
    ds_read_b64_tr_b16 v[234:235], v15 offset:19456
    ds_read_b64_tr_b16 v[236:237], v16 offset:18432
    ds_read_b64_tr_b16 v[238:239], v16 offset:19456
    ds_read_b64_tr_b16 v[240:241], v15 offset:20480
    ds_read_b64_tr_b16 v[242:243], v15 offset:21504
    ds_read_b64_tr_b16 v[244:245], v16 offset:20480
    ds_read_b64_tr_b16 v[246:247], v16 offset:21504
    ds_read_b64_tr_b16 v[248:249], v15 offset:22528
    ds_read_b64_tr_b16 v[250:251], v15 offset:23552
    ds_read_b64_tr_b16 v[252:253], v16 offset:22528
    ds_read_b64_tr_b16 v[254:255], v16 offset:23552
    s_add_u32 m0, s52, 49152
    s_mul_i32 s58, s69, 229376
    s_add_u32 s58, s58, s59
    buffer_load_dwordx4 v7, s[36:39], s58 offen lds
    buffer_load_dwordx4 v8, s[36:39], s58 offen offset:1024 lds
    s_add_u32 m0, s52, 51200
    s_mul_i32 s58, s69, 229376
    s_add_u32 s58, s58, s59
    s_add_u32 s58, s58, 14336
    buffer_load_dwordx4 v7, s[36:39], s58 offen lds
    buffer_load_dwordx4 v8, s[36:39], s58 offen offset:1024 lds
    s_add_u32 m0, s52, 131072
    s_mul_i32 s58, s70, 229376
    s_add_u32 s58, s58, s59
    buffer_load_dwordx4 v7, s[36:39], s58 offen lds
    buffer_load_dwordx4 v8, s[36:39], s58 offen offset:1024 lds
    s_add_u32 m0, s52, 133120
    s_mul_i32 s58, s70, 229376
    s_add_u32 s58, s58, s59
    s_add_u32 s58, s58, 14336
    buffer_load_dwordx4 v7, s[36:39], s58 offen lds
    buffer_load_dwordx4 v8, s[36:39], s58 offen offset:1024 lds
    s_waitcnt lgkmcnt(0)
    s_barrier
    s_add_u32 m0, s52, 65536
    s_mul_i32 s58, s64, 229376
    s_add_u32 s58, s58, s59
    s_add_u32 s58, s58, 57344
    buffer_load_dwordx4 v7, s[36:39], s58 offen lds
    buffer_load_dwordx4 v8, s[36:39], s58 offen offset:1024 lds
    s_add_u32 m0, s52, 67584
    s_mul_i32 s58, s64, 229376
    s_add_u32 s58, s58, s59
    s_add_u32 s58, s58, 71680
    buffer_load_dwordx4 v7, s[36:39], s58 offen lds
    buffer_load_dwordx4 v8, s[36:39], s58 offen offset:1024 lds
    s_add_u32 m0, s52, 81920
    s_mul_i32 s58, s65, 229376
    s_add_u32 s58, s58, s59
    s_add_u32 s58, s58, 57344
    buffer_load_dwordx4 v7, s[36:39], s58 offen lds
    buffer_load_dwordx4 v8, s[36:39], s58 offen offset:1024 lds
    s_add_u32 m0, s52, 83968
    s_mul_i32 s58, s65, 229376
    s_add_u32 s58, s58, s59
    s_add_u32 s58, s58, 71680
    buffer_load_dwordx4 v7, s[36:39], s58 offen lds
    buffer_load_dwordx4 v8, s[36:39], s58 offen offset:1024 lds
    s_add_u32 m0, s52, 16384
    s_mul_i32 s58, s66, 229376
    s_add_u32 s58, s58, s59
    s_add_u32 s58, s58, 57344
    buffer_load_dwordx4 v7, s[36:39], s58 offen lds
    buffer_load_dwordx4 v8, s[36:39], s58 offen offset:1024 lds
    s_add_u32 m0, s52, 18432
    s_mul_i32 s58, s66, 229376
    s_add_u32 s58, s58, s59
    s_add_u32 s58, s58, 71680
    buffer_load_dwordx4 v7, s[36:39], s58 offen lds
    buffer_load_dwordx4 v8, s[36:39], s58 offen offset:1024 lds
    s_waitcnt vmcnt(12)
    s_barrier
    s_add_u32 m0, s52, 147456
    s_mul_i32 s58, s67, 229376
    s_add_u32 s58, s58, s59
    s_add_u32 s58, s58, 57344
    buffer_load_dwordx4 v7, s[36:39], s58 offen lds
    buffer_load_dwordx4 v8, s[36:39], s58 offen offset:1024 lds
    s_add_u32 m0, s52, 149504
    s_mul_i32 s58, s67, 229376
    s_add_u32 s58, s58, s59
    s_add_u32 s58, s58, 71680
    buffer_load_dwordx4 v7, s[36:39], s58 offen lds
    buffer_load_dwordx4 v8, s[36:39], s58 offen offset:1024 lds
    s_add_u32 m0, s52, 0
    s_mul_i32 s58, s68, 229376
    s_add_u32 s58, s58, s59
    s_add_u32 s58, s58, 57344
    buffer_load_dwordx4 v7, s[36:39], s58 offen lds
    buffer_load_dwordx4 v8, s[36:39], s58 offen offset:1024 lds
    s_add_u32 m0, s52, 2048
    s_mul_i32 s58, s68, 229376
    s_add_u32 s58, s58, s59
    s_add_u32 s58, s58, 71680
    buffer_load_dwordx4 v7, s[36:39], s58 offen lds
    buffer_load_dwordx4 v8, s[36:39], s58 offen offset:1024 lds
    s_mov_b64 exec, 0x7f
    global_load_dword v13, v12, s[16:17] offset:0 sc1
    s_mov_b64 exec, -1
    s_waitcnt vmcnt(0)
    s_mov_b64 exec, 0x7f
    v_cmp_ne_u32 vcc, s61, v13
    s_cbranch_vccz L_pok_3
L_plp_4:
    s_sleep 2
    global_load_dword v13, v12, s[16:17] offset:0 sc1
    s_waitcnt vmcnt(0)
    v_cmp_ne_u32 vcc, s61, v13
    s_cbranch_vccnz L_plp_4
L_pok_3:
    s_mov_b64 exec, -1
    s_lshl_b32 s57, s64, 14
    s_add_u32 s57, s57, s60
    buffer_load_dwordx4 v[36:39], v9, s[32:35], s57 offen offset:0 sc1
    s_lshl_b32 s57, s64, 14
    s_add_u32 s57, s57, s60
    buffer_load_dwordx4 v[40:43], v9, s[32:35], s57 offen offset:1024 sc1
    s_lshl_b32 s57, s64, 14
    s_add_u32 s57, s57, s60
    buffer_load_dwordx4 v[44:47], v9, s[32:35], s57 offen offset:2048 sc1
    s_lshl_b32 s57, s64, 14
    s_add_u32 s57, s57, s60
    buffer_load_dwordx4 v[48:51], v9, s[32:35], s57 offen offset:3072 sc1
    s_lshl_b32 s57, s65, 14
    s_add_u32 s57, s57, s60
    buffer_load_dwordx4 v[52:55], v9, s[32:35], s57 offen offset:0 sc1
    s_lshl_b32 s57, s65, 14
    s_add_u32 s57, s57, s60
    buffer_load_dwordx4 v[100:103], v9, s[32:35], s57 offen offset:1024 sc1
    s_lshl_b32 s57, s65, 14
    s_add_u32 s57, s57, s60
    buffer_load_dwordx4 v[104:107], v9, s[32:35], s57 offen offset:2048 sc1
    s_lshl_b32 s57, s65, 14
    s_add_u32 s57, s57, s60
    buffer_load_dwordx4 v[108:111], v9, s[32:35], s57 offen offset:3072 sc1
    s_lshl_b32 s57, s66, 14
    s_add_u32 s57, s57, s60
    buffer_load_dwordx4 v[112:115], v9, s[32:35], s57 offen offset:0 sc1
    s_lshl_b32 s57, s66, 14
    s_add_u32 s57, s57, s60
    buffer_load_dwordx4 v[116:119], v9, s[32:35], s57 offen offset:1024 sc1
    s_lshl_b32 s57, s66, 14
    s_add_u32 s57, s57, s60
    buffer_load_dwordx4 v[120:123], v9, s[32:35], s57 offen offset:2048 sc1
    s_lshl_b32 s57, s66, 14
    s_add_u32 s57, s57, s60
    buffer_load_dwordx4 v[124:127], v9, s[32:35], s57 offen offset:3072 sc1
    s_lshl_b32 s57, s67, 14
    s_add_u32 s57, s57, s60
    buffer_load_dwordx4 v[128:131], v9, s[32:35], s57 offen offset:0 sc1
    s_lshl_b32 s57, s67, 14
    s_add_u32 s57, s57, s60
    buffer_load_dwordx4 v[132:135], v9, s[32:35], s57 offen offset:1024 sc1
    s_lshl_b32 s57, s67, 14
    s_add_u32 s57, s57, s60
    buffer_load_dwordx4 v[136:139], v9, s[32:35], s57 offen offset:2048 sc1
    s_lshl_b32 s57, s67, 14
    s_add_u32 s57, s57, s60
    buffer_load_dwordx4 v[140:143], v9, s[32:35], s57 offen offset:3072 sc1
    s_lshl_b32 s57, s68, 14
    s_add_u32 s57, s57, s60
    buffer_load_dwordx4 v[144:147], v9, s[32:35], s57 offen offset:0 sc1
    s_lshl_b32 s57, s68, 14
    s_add_u32 s57, s57, s60
    buffer_load_dwordx4 v[148:151], v9, s[32:35], s57 offen offset:1024 sc1
    s_lshl_b32 s57, s68, 14
    s_add_u32 s57, s57, s60
    buffer_load_dwordx4 v[152:155], v9, s[32:35], s57 offen offset:2048 sc1
    s_lshl_b32 s57, s68, 14
    s_add_u32 s57, s57, s60
    buffer_load_dwordx4 v[156:159], v9, s[32:35], s57 offen offset:3072 sc1
    s_lshl_b32 s57, s69, 14
    s_add_u32 s57, s57, s60
    buffer_load_dwordx4 v[160:163], v9, s[32:35], s57 offen offset:0 sc1
    s_lshl_b32 s57, s69, 14
    s_add_u32 s57, s57, s60
    buffer_load_dwordx4 v[164:167], v9, s[32:35], s57 offen offset:1024 sc1
    s_lshl_b32 s57, s69, 14
    s_add_u32 s57, s57, s60
    buffer_load_dwordx4 v[168:171], v9, s[32:35], s57 offen offset:2048 sc1
    s_lshl_b32 s57, s69, 14
    s_add_u32 s57, s57, s60
    buffer_load_dwordx4 v[172:175], v9, s[32:35], s57 offen offset:3072 sc1
    s_lshl_b32 s57, s70, 14
    s_add_u32 s57, s57, s60
    buffer_load_dwordx4 v[176:179], v9, s[32:35], s57 offen offset:0 sc1
    s_lshl_b32 s57, s70, 14
    s_add_u32 s57, s57, s60
    buffer_load_dwordx4 v[180:183], v9, s[32:35], s57 offen offset:1024 sc1
    s_lshl_b32 s57, s70, 14
    s_add_u32 s57, s57, s60
    buffer_load_dwordx4 v[184:187], v9, s[32:35], s57 offen offset:2048 sc1
    s_lshl_b32 s57, s70, 14
    s_add_u32 s57, s57, s60
    buffer_load_dwordx4 v[188:191], v9, s[32:35], s57 offen offset:3072 sc1
    s_waitcnt vmcnt(27)
    v_mfma_f32_32x32x16_bf16 v[68:83], v[192:195], v[36:39], 0
    v_mfma_f32_32x32x16_bf16 v[84:99], v[196:199], v[36:39], 0
    s_waitcnt vmcnt(26)
    v_mfma_f32_32x32x16_bf16 v[68:83], v[200:203], v[40:43], v[68:83]
    v_mfma_f32_32x32x16_bf16 v[84:99], v[204:207], v[40:43], v[84:99]
    s_waitcnt vmcnt(25)
    v_mfma_f32_32x32x16_bf16 v[68:83], v[208:211], v[44:47], v[68:83]
    v_mfma_f32_32x32x16_bf16 v[84:99], v[212:215], v[44:47], v[84:99]
    s_waitcnt vmcnt(24)
    v_mfma_f32_32x32x16_bf16 v[68:83], v[216:219], v[48:51], v[68:83]
    v_mfma_f32_32x32x16_bf16 v[84:99], v[220:223], v[48:51], v[84:99]
    s_waitcnt vmcnt(23)
    v_mfma_f32_32x32x16_bf16 v[68:83], v[224:227], v[52:55], v[68:83]
    v_mfma_f32_32x32x16_bf16 v[84:99], v[228:231], v[52:55], v[84:99]
    s_waitcnt vmcnt(22)
    v_mfma_f32_32x32x16_bf16 v[68:83], v[232:235], v[100:103], v[68:83]
    v_mfma_f32_32x32x16_bf16 v[84:99], v[236:239], v[100:103], v[84:99]
    ds_read_b64_tr_b16 v[36:37], v17 offset:32768
    ds_read_b64_tr_b16 v[38:39], v17 offset:33792
    ds_read_b64_tr_b16 v[40:41], v18 offset:32768
    ds_read_b64_tr_b16 v[42:43], v18 offset:33792
    s_waitcnt vmcnt(21)
    v_mfma_f32_32x32x16_bf16 v[68:83], v[240:243], v[104:107], v[68:83]
    v_mfma_f32_32x32x16_bf16 v[84:99], v[244:247], v[104:107], v[84:99]
    ds_read_b64_tr_b16 v[44:45], v17 offset:34816
    ds_read_b64_tr_b16 v[46:47], v17 offset:35840
    ds_read_b64_tr_b16 v[48:49], v18 offset:34816
    ds_read_b64_tr_b16 v[50:51], v18 offset:35840
    s_waitcnt vmcnt(20)
    v_mfma_f32_32x32x16_bf16 v[68:83], v[248:251], v[108:111], v[68:83]
    v_mfma_f32_32x32x16_bf16 v[84:99], v[252:255], v[108:111], v[84:99]
    ds_read_b64_tr_b16 v[52:53], v17 offset:36864
    ds_read_b64_tr_b16 v[54:55], v17 offset:37888
    ds_read_b64_tr_b16 v[56:57], v18 offset:36864
    ds_read_b64_tr_b16 v[58:59], v18 offset:37888
    s_waitcnt vmcnt(19)
    s_waitcnt lgkmcnt(8)
    v_mfma_f32_32x32x16_bf16 v[68:83], v[36:39], v[112:115], v[68:83]
    v_mfma_f32_32x32x16_bf16 v[84:99], v[40:43], v[112:115], v[84:99]
    ds_read_b64_tr_b16 v[60:61], v17 offset:38912
    ds_read_b64_tr_b16 v[62:63], v17 offset:39936
    ds_read_b64_tr_b16 v[64:65], v18 offset:38912
    ds_read_b64_tr_b16 v[66:67], v18 offset:39936
    s_waitcnt vmcnt(18)
    s_waitcnt lgkmcnt(8)
    v_mfma_f32_32x32x16_bf16 v[68:83], v[44:47], v[116:119], v[68:83]
    v_mfma_f32_32x32x16_bf16 v[84:99], v[48:51], v[116:119], v[84:99]
    ds_read_b64_tr_b16 v[36:37], v15 offset:32768
    ds_read_b64_tr_b16 v[38:39], v15 offset:33792
    ds_read_b64_tr_b16 v[40:41], v16 offset:32768
    ds_read_b64_tr_b16 v[42:43], v16 offset:33792
    s_waitcnt vmcnt(17)
    s_waitcnt lgkmcnt(8)
    v_mfma_f32_32x32x16_bf16 v[68:83], v[52:55], v[120:123], v[68:83]
    v_mfma_f32_32x32x16_bf16 v[84:99], v[56:59], v[120:123], v[84:99]
    ds_read_b64_tr_b16 v[44:45], v15 offset:34816
    ds_read_b64_tr_b16 v[46:47], v15 offset:35840
    ds_read_b64_tr_b16 v[48:49], v16 offset:34816
    ds_read_b64_tr_b16 v[50:51], v16 offset:35840
    s_waitcnt vmcnt(16)
    s_waitcnt lgkmcnt(8)
    v_mfma_f32_32x32x16_bf16 v[68:83], v[60:63], v[124:127], v[68:83]
    v_mfma_f32_32x32x16_bf16 v[84:99], v[64:67], v[124:127], v[84:99]
    ds_read_b64_tr_b16 v[52:53], v15 offset:36864
    ds_read_b64_tr_b16 v[54:55], v15 offset:37888
    ds_read_b64_tr_b16 v[56:57], v16 offset:36864
    ds_read_b64_tr_b16 v[58:59], v16 offset:37888
    s_waitcnt vmcnt(15)
    s_waitcnt lgkmcnt(8)
    v_mfma_f32_32x32x16_bf16 v[68:83], v[36:39], v[128:131], v[68:83]
    v_mfma_f32_32x32x16_bf16 v[84:99], v[40:43], v[128:131], v[84:99]
    ds_read_b64_tr_b16 v[60:61], v15 offset:38912
    ds_read_b64_tr_b16 v[62:63], v15 offset:39936
    ds_read_b64_tr_b16 v[64:65], v16 offset:38912
    ds_read_b64_tr_b16 v[66:67], v16 offset:39936
    s_waitcnt vmcnt(14)
    s_waitcnt lgkmcnt(8)
    v_mfma_f32_32x32x16_bf16 v[68:83], v[44:47], v[132:135], v[68:83]
    v_mfma_f32_32x32x16_bf16 v[84:99], v[48:51], v[132:135], v[84:99]
    ds_read_b64_tr_b16 v[36:37], v17 offset:49152
    ds_read_b64_tr_b16 v[38:39], v17 offset:50176
    ds_read_b64_tr_b16 v[40:41], v18 offset:49152
    ds_read_b64_tr_b16 v[42:43], v18 offset:50176
    s_waitcnt vmcnt(13)
    s_waitcnt lgkmcnt(8)
    v_mfma_f32_32x32x16_bf16 v[68:83], v[52:55], v[136:139], v[68:83]
    v_mfma_f32_32x32x16_bf16 v[84:99], v[56:59], v[136:139], v[84:99]
    ds_read_b64_tr_b16 v[44:45], v17 offset:51200
    ds_read_b64_tr_b16 v[46:47], v17 offset:52224
    ds_read_b64_tr_b16 v[48:49], v18 offset:51200
    ds_read_b64_tr_b16 v[50:51], v18 offset:52224
    s_waitcnt vmcnt(12)
    s_waitcnt lgkmcnt(8)
    v_mfma_f32_32x32x16_bf16 v[68:83], v[60:63], v[140:143], v[68:83]
    v_mfma_f32_32x32x16_bf16 v[84:99], v[64:67], v[140:143], v[84:99]
    ds_read_b64_tr_b16 v[52:53], v17 offset:53248
    ds_read_b64_tr_b16 v[54:55], v17 offset:54272
    ds_read_b64_tr_b16 v[56:57], v18 offset:53248
    ds_read_b64_tr_b16 v[58:59], v18 offset:54272
    s_barrier
    s_add_u32 m0, s52, 98304
    s_mul_i32 s58, s69, 229376
    s_add_u32 s58, s58, s59
    s_add_u32 s58, s58, 57344
    buffer_load_dwordx4 v7, s[36:39], s58 offen lds
    buffer_load_dwordx4 v8, s[36:39], s58 offen offset:1024 lds
    s_add_u32 m0, s52, 100352
    s_mul_i32 s58, s69, 229376
    s_add_u32 s58, s58, s59
    s_add_u32 s58, s58, 71680
    buffer_load_dwordx4 v7, s[36:39], s58 offen lds
    buffer_load_dwordx4 v8, s[36:39], s58 offen offset:1024 lds
    s_add_u32 m0, s52, 32768
    s_mul_i32 s58, s70, 229376
    s_add_u32 s58, s58, s59
    s_add_u32 s58, s58, 57344
    buffer_load_dwordx4 v7, s[36:39], s58 offen lds
    buffer_load_dwordx4 v8, s[36:39], s58 offen offset:1024 lds
    s_add_u32 m0, s52, 34816
    s_mul_i32 s58, s70, 229376
    s_add_u32 s58, s58, s59
    s_add_u32 s58, s58, 71680
    buffer_load_dwordx4 v7, s[36:39], s58 offen lds
    buffer_load_dwordx4 v8, s[36:39], s58 offen offset:1024 lds
    s_waitcnt vmcnt(19)
    s_waitcnt lgkmcnt(8)
    v_mfma_f32_32x32x16_bf16 v[68:83], v[36:39], v[144:147], v[68:83]
    v_mfma_f32_32x32x16_bf16 v[84:99], v[40:43], v[144:147], v[84:99]
    ds_read_b64_tr_b16 v[60:61], v17 offset:55296
    ds_read_b64_tr_b16 v[62:63], v17 offset:56320
    ds_read_b64_tr_b16 v[64:65], v18 offset:55296
    ds_read_b64_tr_b16 v[66:67], v18 offset:56320
    s_waitcnt vmcnt(18)
    s_waitcnt lgkmcnt(8)
    v_mfma_f32_32x32x16_bf16 v[68:83], v[44:47], v[148:151], v[68:83]
    v_mfma_f32_32x32x16_bf16 v[84:99], v[48:51], v[148:151], v[84:99]
    ds_read_b64_tr_b16 v[36:37], v15 offset:49152
    ds_read_b64_tr_b16 v[38:39], v15 offset:50176
    ds_read_b64_tr_b16 v[40:41], v16 offset:49152
    ds_read_b64_tr_b16 v[42:43], v16 offset:50176
    s_waitcnt vmcnt(17)
    s_waitcnt lgkmcnt(8)
    v_mfma_f32_32x32x16_bf16 v[68:83], v[52:55], v[152:155], v[68:83]
    v_mfma_f32_32x32x16_bf16 v[84:99], v[56:59], v[152:155], v[84:99]
    ds_read_b64_tr_b16 v[44:45], v15 offset:51200
    ds_read_b64_tr_b16 v[46:47], v15 offset:52224
    ds_read_b64_tr_b16 v[48:49], v16 offset:51200
    ds_read_b64_tr_b16 v[50:51], v16 offset:52224
    s_waitcnt vmcnt(16)
    s_waitcnt lgkmcnt(8)
    v_mfma_f32_32x32x16_bf16 v[68:83], v[60:63], v[156:159], v[68:83]
    v_mfma_f32_32x32x16_bf16 v[84:99], v[64:67], v[156:159], v[84:99]
    ds_read_b64_tr_b16 v[52:53], v15 offset:53248
    ds_read_b64_tr_b16 v[54:55], v15 offset:54272
    ds_read_b64_tr_b16 v[56:57], v16 offset:53248
    ds_read_b64_tr_b16 v[58:59], v16 offset:54272
    s_waitcnt vmcnt(15)
    s_waitcnt lgkmcnt(8)
    v_mfma_f32_32x32x16_bf16 v[68:83], v[36:39], v[160:163], v[68:83]
    v_mfma_f32_32x32x16_bf16 v[84:99], v[40:43], v[160:163], v[84:99]
    ds_read_b64_tr_b16 v[60:61], v15 offset:55296
    ds_read_b64_tr_b16 v[62:63], v15 offset:56320
    ds_read_b64_tr_b16 v[64:65], v16 offset:55296
    ds_read_b64_tr_b16 v[66:67], v16 offset:56320
    s_waitcnt vmcnt(14)
    s_waitcnt lgkmcnt(8)
    v_mfma_f32_32x32x16_bf16 v[68:83], v[44:47], v[164:167], v[68:83]
    v_mfma_f32_32x32x16_bf16 v[84:99], v[48:51], v[164:167], v[84:99]
    ds_read_b64_tr_b16 v[36:37], v19 offset:0
    ds_read_b64_tr_b16 v[38:39], v19 offset:1024
    ds_read_b64_tr_b16 v[40:41], v20 offset:0
    ds_read_b64_tr_b16 v[42:43], v20 offset:1024
    s_waitcnt vmcnt(13)
    s_waitcnt lgkmcnt(8)
    v_mfma_f32_32x32x16_bf16 v[68:83], v[52:55], v[168:171], v[68:83]
    v_mfma_f32_32x32x16_bf16 v[84:99], v[56:59], v[168:171], v[84:99]
    ds_read_b64_tr_b16 v[44:45], v19 offset:2048
    ds_read_b64_tr_b16 v[46:47], v19 offset:3072
    ds_read_b64_tr_b16 v[48:49], v20 offset:2048
    ds_read_b64_tr_b16 v[50:51], v20 offset:3072
    s_waitcnt vmcnt(12)
    s_waitcnt lgkmcnt(8)
    v_mfma_f32_32x32x16_bf16 v[68:83], v[60:63], v[172:175], v[68:83]
    v_mfma_f32_32x32x16_bf16 v[84:99], v[64:67], v[172:175], v[84:99]
    ds_read_b64_tr_b16 v[52:53], v19 offset:4096
    ds_read_b64_tr_b16 v[54:55], v19 offset:5120
    ds_read_b64_tr_b16 v[56:57], v20 offset:4096
    ds_read_b64_tr_b16 v[58:59], v20 offset:5120
    s_waitcnt vmcnt(11)
    s_waitcnt lgkmcnt(8)
    v_mfma_f32_32x32x16_bf16 v[68:83], v[36:39], v[176:179], v[68:83]
    v_mfma_f32_32x32x16_bf16 v[84:99], v[40:43], v[176:179], v[84:99]
    ds_read_b64_tr_b16 v[60:61], v19 offset:6144
    ds_read_b64_tr_b16 v[62:63], v19 offset:7168
    ds_read_b64_tr_b16 v[64:65], v20 offset:6144
    ds_read_b64_tr_b16 v[66:67], v20 offset:7168
    s_waitcnt vmcnt(10)
    s_waitcnt lgkmcnt(8)
    v_mfma_f32_32x32x16_bf16 v[68:83], v[44:47], v[180:183], v[68:83]
    v_mfma_f32_32x32x16_bf16 v[84:99], v[48:51], v[180:183], v[84:99]
    s_waitcnt vmcnt(9)
    s_waitcnt lgkmcnt(4)
    v_mfma_f32_32x32x16_bf16 v[68:83], v[52:55], v[184:187], v[68:83]
    v_mfma_f32_32x32x16_bf16 v[84:99], v[56:59], v[184:187], v[84:99]
    s_waitcnt vmcnt(8)
    s_waitcnt lgkmcnt(0)
    v_mfma_f32_32x32x16_bf16 v[68:83], v[60:63], v[188:191], v[68:83]
    v_mfma_f32_32x32x16_bf16 v[84:99], v[64:67], v[188:191], v[84:99]
    s_waitcnt vmcnt(0)
    s_barrier
    s_lshl_b32 s55, s62, 13
    s_mul_i32 s56, s63, -65536
    s_add_u32 s56, s56, 114688
    s_add_u32 s55, s55, s56
    v_add_u32 v13, s55, v9
    s_nop 7
    ds_write_b128 v13, v[68:71] offset:0
    ds_write_b128 v13, v[72:75] offset:1024
    ds_write_b128 v13, v[76:79] offset:2048
    ds_write_b128 v13, v[80:83] offset:3072
    ds_write_b128 v13, v[84:87] offset:4096
    ds_write_b128 v13, v[88:91] offset:5120
    ds_write_b128 v13, v[92:95] offset:6144
    ds_write_b128 v13, v[96:99] offset:7168
    s_waitcnt lgkmcnt(0)
    s_barrier
    s_endpgm
L_B:
    s_add_u32 m0, s52, 81920
    s_mul_i32 s58, s100, 229376
    s_add_u32 s58, s58, s51
    buffer_load_dwordx4 v3, s[24:27], s58 offen lds
    buffer_load_dwordx4 v4, s[24:27], s58 offen offset:2048 lds
    s_add_u32 m0, s52, 82944
    s_mul_i32 s58, s100, 229376
    s_add_u32 s58, s58, s51
    buffer_load_dwordx4 v5, s[28:31], s58 offen lds
    buffer_load_dwordx4 v6, s[28:31], s58 offen offset:2048 lds
    s_mov_b32 s32, s16
    s_and_b32 s33, s17, 0xffff
    s_mov_b32 s34, 0x10000000
    s_mov_b32 s35, 0x20000
    s_mov_b32 s36, s10
    s_and_b32 s37, s11, 0xffff
    s_mov_b32 s38, 0x188000
    s_mov_b32 s39, 0x20000
    s_mov_b32 s40, s12
    s_and_b32 s41, s13, 0xffff
    s_mov_b32 s42, 0x1c0000
    s_mov_b32 s43, 0x20000
    s_add_u32 s5, s3, 1
    s_mov_b32 s4, 0
    s_add_u32 s6, s5, 1
    s_cmp_ge_u32 s6, 7
    s_cselect_b32 s6, 1, s6
    s_add_u32 s7, s6, 1
    s_cmp_ge_u32 s7, 7
    s_cselect_b32 s7, 1, s7
    s_add_u32 s8, s7, 1
    s_cmp_ge_u32 s8, 7
    s_cselect_b32 s8, 1, s8
    s_add_u32 s9, s8, 1
    s_cmp_ge_u32 s9, 7
    s_cselect_b32 s9, 1, s9
    s_add_u32 s10, s9, 1
    s_cmp_ge_u32 s10, 7
    s_cselect_b32 s10, 1, s10
    s_add_u32 m0, s52, 98304
    s_mul_i32 s58, s5, 229376
    s_add_u32 s58, s58, s51
    buffer_load_dwordx4 v3, s[24:27], s58 offen lds
    buffer_load_dwordx4 v4, s[24:27], s58 offen offset:2048 lds
    s_add_u32 m0, s52, 99328
    s_mul_i32 s58, s5, 229376
    s_add_u32 s58, s58, s51
    buffer_load_dwordx4 v5, s[28:31], s58 offen lds
    buffer_load_dwordx4 v6, s[28:31], s58 offen offset:2048 lds
    s_add_u32 m0, s52, 114688
    s_mul_i32 s58, s6, 229376
    s_add_u32 s58, s58, s51
    buffer_load_dwordx4 v3, s[24:27], s58 offen lds
    buffer_load_dwordx4 v4, s[24:27], s58 offen offset:2048 lds
    s_add_u32 m0, s52, 115712
    s_mul_i32 s58, s6, 229376
    s_add_u32 s58, s58, s51
    buffer_load_dwordx4 v5, s[28:31], s58 offen lds
    buffer_load_dwordx4 v6, s[28:31], s58 offen offset:2048 lds
    v_lshrrev_b32 v44, 5, v0
    v_lshlrev_b32 v44, 11, v44
    v_bfe_u32 v45, v0, 4, 1
    v_lshl_add_u32 v44, v45, 10, v44
    v_bfe_u32 v46, v0, 2, 2
    v_lshl_add_u32 v44, v46, 7, v44
    v_and_b32 v47, 3, v0
    v_lshl_add_u32 v44, v47, 3, v44
    v_lshrrev_b32 v46, 1, v46
    v_lshl_or_b32 v46, v45, 1, v46
    v_lshl_add_u32 v15, v46, 5, v44
    v_xor_b32 v16, 32, v15
    v_xor_b32 v17, 64, v15
    v_xor_b32 v18, 96, v15
    v_add_u32 v19, 0x10000, v15
    v_add_u32 v20, 0x10000, v16
    v_add_u32 v21, 0x10000, v17
    v_add_u32 v22, 0x10000, v18
    v_add_u32 v23, 0x20000, v15
    v_add_u32 v24, 0x20000, v16
    v_add_u32 v25, 0x20000, v17
    v_add_u32 v26, 0x20000, v18
    v_and_b32 v44, 31, v0
    v_bfe_u32 v45, v0, 1, 3
    v_lshrrev_b32 v46, 5, v0
    v_xor_b32 v45, v45, v46
    v_lshlrev_b32 v44, 7, v44
    v_lshl_add_u32 v44, v45, 4, v44
    v_add_u32 v27, s52, v44
    v_xor_b32 v28, 32, v27
    v_xor_b32 v29, 64, v27
    v_xor_b32 v30, 96, v27
    v_add_u32 v31, 0x10000, v27
    v_add_u32 v32, 0x10000, v28
    v_add_u32 v33, 0x10000, v29
    v_add_u32 v34, 0x10000, v30
    v_lshlrev_b32 v9, 4, v0
    v_mov_b32 v10, 0xbdd2d3e8
    s_mov_b32 s54, 0xc0135761
    s_lshl_b32 s56, s46, 2
    s_add_u32 s56, s56, s45
    s_mul_i32 s53, s56, 112
    s_lshl_b32 s55, s47, 3
    s_add_u32 s53, s53, s55
    s_and_b32 s55, s44, 4
    s_add_u32 s53, s53, s55
    s_lshl_b32 s53, s53, 10
    s_lshl_b32 s56, s56, 8
    s_lshl_b32 s55, s47, 2
    s_add_u32 s56, s56, s55
    s_add_u32 s56, s56, 0x800000
    v_mov_b32 v11, s56
    v_lshrrev_b32 v44, 3, v0
    v_and_b32 v45, 7, v0
    v_lshrrev_b32 v46, 2, v45
    v_bfe_u32 v47, v44, 1, 1
    v_xor_b32 v46, v46, v47
    v_and_b32 v47, 3, v45
    v_lshl_add_u32 v47, v46, 2, v47
    v_lshlrev_b32 v47, 4, v47
    v_mul_u32_u24 v48, 896, v44
    v_add_u32 v7, v48, v47
    v_add_u32 v8, 6144, v7
    s_lshl_b32 s59, s63, 7
    s_lshl_b32 s55, s62, 5
    s_add_u32 s59, s59, s55
    s_mul_i32 s59, s59, 896
    s_lshl_b32 s55, s49, 7
    s_add_u32 s59, s59, s55
    v_lshrrev_b32 v44, 5, v0
    v_lshlrev_b32 v44, 9, v44
    v_bfe_u32 v45, v0, 2, 2
    v_lshl_add_u32 v44, v45, 7, v44
    v_bfe_u32 v46, v0, 4, 1
    v_lshl_add_u32 v44, v46, 5, v44
    v_and_b32 v46, 3, v0
    v_lshl_add_u32 v44, v46, 3, v44
    s_lshl_b32 s55, s63, 13
    v_add_u32 v44, s55, v44
    v_lshrrev_b32 v45, 1, v45
    v_lshl_add_u32 v35, v45, 6, v44
    s_lshl_b32 s56, s48, 1
    s_add_u32 s56, s56, s62
    s_mul_i32 s60, s56, 112
    s_lshl_b32 s55, s63, 3
    s_add_u32 s60, s60, s55
    s_and_b32 s55, s44, 4
    s_add_u32 s60, s60, s55
    s_lshl_b32 s60, s60, 10
    s_lshl_b32 s56, s56, 8
    s_lshl_b32 s55, s63, 2
    s_add_u32 s56, s56, s55
    s_add_u32 s56, s56, 0x800000
    v_lshlrev_b32 v44, 3, v0
    v_add_u32 v12, s56, v44
    s_mov_b64 exec, 1
    v_mov_b32 v36, 0
    buffer_load_dword v37, v36, s[36:39], s59 offen
    buffer_load_dword v38, v36, s[32:35], s53 offen
    buffer_load_dword v39, v36, s[32:35], s60 offen
    global_load_dword v40, v11, s[16:17]
    s_mul_i32 s55, s48, 57344
    buffer_load_dword v41, v36, s[40:43], s55 offen
    s_add_u32 s55, s59, 917504
    buffer_load_dword v42, v36, s[36:39], s55 offen
    s_mov_b64 exec, -1
    s_waitcnt vmcnt(14)
    s_barrier
    ds_read_b128 v[144:147], v27 offset:0
    ds_read_b128 v[148:151], v28 offset:0
    ds_read_b128 v[152:155], v29 offset:0
    ds_read_b128 v[156:159], v30 offset:0
    s_add_u32 m0, s52, 49152
    s_mul_i32 s58, s7, 128
    s_add_u32 s58, s58, s50
    buffer_load_dwordx4 v1, s[20:23], s58 offen lds
    buffer_load_dwordx4 v2, s[20:23], s58 offen offset:1024 lds
    s_add_u32 m0, s52, 51200
    s_mul_i32 s58, s7, 128
    s_add_u32 s58, s58, s50
    s_add_u32 s58, s58, 14336
    buffer_load_dwordx4 v1, s[20:23], s58 offen lds
    buffer_load_dwordx4 v2, s[20:23], s58 offen offset:1024 lds
    s_add_u32 m0, s52, 131072
    s_mul_i32 s58, s7, 229376
    s_add_u32 s58, s58, s51
    buffer_load_dwordx4 v3, s[24:27], s58 offen lds
    buffer_load_dwordx4 v4, s[24:27], s58 offen offset:2048 lds
    s_add_u32 m0, s52, 132096
    s_mul_i32 s58, s7, 229376
    s_add_u32 s58, s58, s51
    buffer_load_dwordx4 v5, s[28:31], s58 offen lds
    buffer_load_dwordx4 v6, s[28:31], s58 offen offset:2048 lds
    s_add_u32 m0, s52, 65536
    s_mul_i32 s58, s8, 128
    s_add_u32 s58, s58, s50
    buffer_load_dwordx4 v1, s[20:23], s58 offen lds
    buffer_load_dwordx4 v2, s[20:23], s58 offen offset:1024 lds
    s_waitcnt lgkmcnt(0)
    s_waitcnt vmcnt(20)
    s_barrier
    ds_read_b128 v[160:163], v27 offset:16384
    ds_read_b128 v[164:167], v28 offset:16384
    ds_read_b128 v[168:171], v29 offset:16384
    ds_read_b128 v[172:175], v30 offset:16384
    s_add_u32 m0, s52, 67584
    s_mul_i32 s58, s8, 128
    s_add_u32 s58, s58, s50
    s_add_u32 s58, s58, 14336
    buffer_load_dwordx4 v1, s[20:23], s58 offen lds
    buffer_load_dwordx4 v2, s[20:23], s58 offen offset:1024 lds
    s_add_u32 m0, s52, 147456
    s_mul_i32 s58, s8, 229376
    s_add_u32 s58, s58, s51
    buffer_load_dwordx4 v3, s[24:27], s58 offen lds
    buffer_load_dwordx4 v4, s[24:27], s58 offen offset:2048 lds
    s_add_u32 m0, s52, 148480
    s_mul_i32 s58, s8, 229376
    s_add_u32 s58, s58, s51
    buffer_load_dwordx4 v5, s[28:31], s58 offen lds
    buffer_load_dwordx4 v6, s[28:31], s58 offen offset:2048 lds
    s_cmp_lg_u32 s44, 4
    s_cbranch_scc1 L_go_5
    s_lshr_b32 s55, s2, 3
    s_cmp_lg_u32 s55, 4
    s_cbranch_scc1 L_go_5
    s_and_b32 s55, s2, 7
    s_lshl_b32 s55, s55, 4
    s_add_u32 s55, s55, 128
    v_mov_b32 v36, s55
    v_mov_b32 v37, 1
    s_mov_b64 exec, 1
    global_store_dword v36, v37, s[14:15] sc0 sc1
    s_mov_b64 exec, -1
L_go_5:
    s_waitcnt lgkmcnt(0)
    s_waitcnt vmcnt(22)
    s_barrier
    ds_read_b128 v[176:179], v27 offset:32768
    ds_read_b128 v[180:183], v28 offset:32768
    ds_read_b128 v[184:187], v29 offset:32768
    ds_read_b128 v[188:191], v30 offset:32768
    s_add_u32 m0, s52, 0
    s_mul_i32 s58, s9, 128
    s_add_u32 s58, s58, s50
    buffer_load_dwordx4 v1, s[20:23], s58 offen lds
    buffer_load_dwordx4 v2, s[20:23], s58 offen offset:1024 lds
    s_add_u32 m0, s52, 2048
    s_mul_i32 s58, s9, 128
    s_add_u32 s58, s58, s50
    s_add_u32 s58, s58, 14336
    buffer_load_dwordx4 v1, s[20:23], s58 offen lds
    buffer_load_dwordx4 v2, s[20:23], s58 offen offset:1024 lds
    s_add_u32 m0, s52, 81920
    s_mul_i32 s58, s9, 229376
    s_add_u32 s58, s58, s51
    buffer_load_dwordx4 v3, s[24:27], s58 offen lds
    buffer_load_dwordx4 v4, s[24:27], s58 offen offset:2048 lds
    s_add_u32 m0, s52, 82944
    s_mul_i32 s58, s9, 229376
    s_add_u32 s58, s58, s51
    buffer_load_dwordx4 v5, s[28:31], s58 offen lds
    buffer_load_dwordx4 v6, s[28:31], s58 offen offset:2048 lds
    s_waitcnt lgkmcnt(0)
    s_waitcnt vmcnt(16)
    s_barrier
    ds_read_b128 v[192:195], v27 offset:49152
    ds_read_b128 v[196:199], v28 offset:49152
    ds_read_b128 v[200:203], v29 offset:49152
    ds_read_b128 v[204:207], v30 offset:49152
    s_add_u32 m0, s52, 16384
    s_mul_i32 s58, s10, 128
    s_add_u32 s58, s58, s50
    buffer_load_dwordx4 v1, s[20:23], s58 offen lds
    buffer_load_dwordx4 v2, s[20:23], s58 offen offset:1024 lds
    s_add_u32 m0, s52, 18432
    s_mul_i32 s58, s10, 128
    s_add_u32 s58, s58, s50
    s_add_u32 s58, s58, 14336
    buffer_load_dwordx4 v1, s[20:23], s58 offen lds
    buffer_load_dwordx4 v2, s[20:23], s58 offen offset:1024 lds
    s_add_u32 m0, s52, 98304
    s_mul_i32 s58, s10, 229376
    s_add_u32 s58, s58, s51
    buffer_load_dwordx4 v3, s[24:27], s58 offen lds
    buffer_load_dwordx4 v4, s[24:27], s58 offen offset:2048 lds
    s_add_u32 m0, s52, 99328
    s_mul_i32 s58, s10, 229376
    s_add_u32 s58, s58, s51
    buffer_load_dwordx4 v5, s[28:31], s58 offen lds
    buffer_load_dwordx4 v6, s[28:31], s58 offen offset:2048 lds
    s_waitcnt lgkmcnt(0)
    s_waitcnt vmcnt(16)
    s_barrier
    ds_read_b128 v[208:211], v31 offset:0
    ds_read_b128 v[212:215], v32 offset:0
    ds_read_b128 v[216:219], v33 offset:0
    ds_read_b128 v[220:223], v34 offset:0
    s_add_u32 m0, s52, 32768
    s_mul_i32 s58, s100, 229376
    s_add_u32 s58, s58, s51
    s_add_u32 s58, s58, 128
    buffer_load_dwordx4 v3, s[24:27], s58 offen lds
    buffer_load_dwordx4 v4, s[24:27], s58 offen offset:2048 lds
    s_add_u32 m0, s52, 33792
    s_mul_i32 s58, s100, 229376
    s_add_u32 s58, s58, s51
    s_add_u32 s58, s58, 128
    buffer_load_dwordx4 v5, s[28:31], s58 offen lds
    buffer_load_dwordx4 v6, s[28:31], s58 offen offset:2048 lds
    s_add_u32 m0, s52, 114688
    s_mul_i32 s58, s5, 229376
    s_add_u32 s58, s58, s51
    s_add_u32 s58, s58, 128
    buffer_load_dwordx4 v3, s[24:27], s58 offen lds
    buffer_load_dwordx4 v4, s[24:27], s58 offen offset:2048 lds
    s_add_u32 m0, s52, 115712
    s_mul_i32 s58, s5, 229376
    s_add_u32 s58, s58, s51
    s_add_u32 s58, s58, 128
    buffer_load_dwordx4 v5, s[28:31], s58 offen lds
    buffer_load_dwordx4 v6, s[28:31], s58 offen offset:2048 lds
    s_waitcnt lgkmcnt(0)
    s_waitcnt vmcnt(16)
    s_barrier
    ds_read_b128 v[224:227], v27 offset:0
    ds_read_b128 v[228:231], v28 offset:0
    ds_read_b128 v[232:235], v29 offset:0
    ds_read_b128 v[236:239], v30 offset:0
    s_add_u32 m0, s52, 49152
    s_mul_i32 s58, s6, 229376
    s_add_u32 s58, s58, s51
    s_add_u32 s58, s58, 128
    buffer_load_dwordx4 v3, s[24:27], s58 offen lds
    buffer_load_dwordx4 v4, s[24:27], s58 offen offset:2048 lds
    s_add_u32 m0, s52, 50176
    s_mul_i32 s58, s6, 229376
    s_add_u32 s58, s58, s51
    s_add_u32 s58, s58, 128
    buffer_load_dwordx4 v5, s[28:31], s58 offen lds
    buffer_load_dwordx4 v6, s[28:31], s58 offen offset:2048 lds
    s_add_u32 m0, s52, 131072
    s_mul_i32 s58, s7, 229376
    s_add_u32 s58, s58, s51
    s_add_u32 s58, s58, 128
    buffer_load_dwordx4 v3, s[24:27], s58 offen lds
    buffer_load_dwordx4 v4, s[24:27], s58 offen offset:2048 lds
    s_add_u32 m0, s52, 132096
    s_mul_i32 s58, s7, 229376
    s_add_u32 s58, s58, s51
    s_add_u32 s58, s58, 128
    buffer_load_dwordx4 v5, s[28:31], s58 offen lds
    buffer_load_dwordx4 v6, s[28:31], s58 offen offset:2048 lds
    v_mov_b32 v14, 0
    global_load_dword v13, v14, s[14:15] sc1
    s_waitcnt lgkmcnt(0)
    s_waitcnt vmcnt(17)
    s_barrier
    ds_read_b128 v[240:243], v27 offset:16384
    ds_read_b128 v[244:247], v28 offset:16384
    ds_read_b128 v[248:251], v29 offset:16384
    ds_read_b128 v[252:255], v30 offset:16384
    s_add_u32 m0, s52, 65536
    s_mul_i32 s58, s8, 229376
    s_add_u32 s58, s58, s51
    s_add_u32 s58, s58, 128
    buffer_load_dwordx4 v3, s[24:27], s58 offen lds
    buffer_load_dwordx4 v4, s[24:27], s58 offen offset:2048 lds
    s_add_u32 m0, s52, 66560
    s_mul_i32 s58, s8, 229376
    s_add_u32 s58, s58, s51
    s_add_u32 s58, s58, 128
    buffer_load_dwordx4 v5, s[28:31], s58 offen lds
    buffer_load_dwordx4 v6, s[28:31], s58 offen offset:2048 lds
    s_add_u32 m0, s52, 147456
    s_mul_i32 s58, s9, 229376
    s_add_u32 s58, s58, s51
    s_add_u32 s58, s58, 128
    buffer_load_dwordx4 v3, s[24:27], s58 offen lds
    buffer_load_dwordx4 v4, s[24:27], s58 offen offset:2048 lds
    s_add_u32 m0, s52, 148480
    s_mul_i32 s58, s9, 229376
    s_add_u32 s58, s58, s51
    s_add_u32 s58, s58, 128
    buffer_load_dwordx4 v5, s[28:31], s58 offen lds
    buffer_load_dwordx4 v6, s[28:31], s58 offen offset:2048 lds
    s_waitcnt lgkmcnt(0)
    s_waitcnt vmcnt(21)
    s_barrier
    ds_read_b64_tr_b16 v[36:37], v15 offset:32768
    ds_read_b64_tr_b16 v[38:39], v15 offset:33280
    ds_read_b64_tr_b16 v[40:41], v16 offset:32768
    ds_read_b64_tr_b16 v[42:43], v16 offset:33280
    ds_read_b64_tr_b16 v[44:45], v17 offset:32768
    ds_read_b64_tr_b16 v[46:47], v17 offset:33280
    ds_read_b64_tr_b16 v[48:49], v18 offset:32768
    ds_read_b64_tr_b16 v[50:51], v18 offset:33280
    ds_read_b64_tr_b16 v[52:53], v15 offset:36864
    ds_read_b64_tr_b16 v[54:55], v15 offset:37376
    ds_read_b64_tr_b16 v[56:57], v16 offset:36864
    ds_read_b64_tr_b16 v[58:59], v16 offset:37376
    s_waitcnt lgkmcnt(10)
    v_mfma_f32_32x32x16_bf16 v[68:83], v[36:39], v[144:147], 0
    ds_read_b64_tr_b16 v[60:61], v17 offset:36864
    ds_read_b64_tr_b16 v[62:63], v17 offset:37376
    s_waitcnt lgkmcnt(10)
    v_mfma_f32_32x32x16_bf16 v[84:99], v[40:43], v[144:147], 0
    ds_read_b64_tr_b16 v[36:37], v18 offset:36864
    ds_read_b64_tr_b16 v[38:39], v18 offset:37376
    s_waitcnt lgkmcnt(10)
    v_mfma_f32_32x32x16_bf16 v[100:115], v[44:47], v[144:147], 0
    ds_read_b64_tr_b16 v[40:41], v15 offset:40960
    ds_read_b64_tr_b16 v[42:43], v15 offset:41472
    s_waitcnt lgkmcnt(10)
    v_mfma_f32_32x32x16_bf16 v[116:131], v[48:51], v[144:147], 0
    ds_read_b64_tr_b16 v[44:45], v16 offset:40960
    ds_read_b64_tr_b16 v[46:47], v16 offset:41472
    s_waitcnt lgkmcnt(10)
    v_mfma_f32_32x32x16_bf16 v[68:83], v[52:55], v[148:151], v[68:83]
    ds_read_b64_tr_b16 v[48:49], v17 offset:40960
    ds_read_b64_tr_b16 v[50:51], v17 offset:41472
    s_waitcnt lgkmcnt(10)
    v_mfma_f32_32x32x16_bf16 v[84:99], v[56:59], v[148:151], v[84:99]
    ds_read_b64_tr_b16 v[52:53], v18 offset:40960
    ds_read_b64_tr_b16 v[54:55], v18 offset:41472
    s_waitcnt lgkmcnt(10)
    v_mfma_f32_32x32x16_bf16 v[100:115], v[60:63], v[148:151], v[100:115]
    ds_read_b64_tr_b16 v[56:57], v15 offset:45056
    ds_read_b64_tr_b16 v[58:59], v15 offset:45568
    s_waitcnt lgkmcnt(10)
    v_mfma_f32_32x32x16_bf16 v[116:131], v[36:39], v[148:151], v[116:131]
    ds_read_b64_tr_b16 v[60:61], v16 offset:45056
    ds_read_b64_tr_b16 v[62:63], v16 offset:45568
    s_waitcnt lgkmcnt(10)
    v_mfma_f32_32x32x16_bf16 v[68:83], v[40:43], v[152:155], v[68:83]
    ds_read_b64_tr_b16 v[36:37], v17 offset:45056
    ds_read_b64_tr_b16 v[38:39], v17 offset:45568
    s_waitcnt lgkmcnt(10)
    v_mfma_f32_32x32x16_bf16 v[84:99], v[44:47], v[152:155], v[84:99]
    ds_read_b64_tr_b16 v[40:41], v18 offset:45056
    ds_read_b64_tr_b16 v[42:43], v18 offset:45568
    s_waitcnt lgkmcnt(10)
    v_mfma_f32_32x32x16_bf16 v[100:115], v[48:51], v[152:155], v[100:115]
    s_waitcnt vmcnt(17)
    s_barrier
    ds_read_b64_tr_b16 v[44:45], v19 offset:49152
    ds_read_b64_tr_b16 v[46:47], v19 offset:49664
    s_waitcnt lgkmcnt(10)
    v_mfma_f32_32x32x16_bf16 v[116:131], v[52:55], v[152:155], v[116:131]
    ds_read_b64_tr_b16 v[48:49], v20 offset:49152
    ds_read_b64_tr_b16 v[50:51], v20 offset:49664
    s_waitcnt lgkmcnt(10)
    v_mfma_f32_32x32x16_bf16 v[68:83], v[56:59], v[156:159], v[68:83]
    ds_read_b64_tr_b16 v[52:53], v21 offset:49152
    ds_read_b64_tr_b16 v[54:55], v21 offset:49664
    s_waitcnt lgkmcnt(10)
    v_mfma_f32_32x32x16_bf16 v[84:99], v[60:63], v[156:159], v[84:99]
    ds_read_b64_tr_b16 v[56:57], v22 offset:49152
    ds_read_b64_tr_b16 v[58:59], v22 offset:49664
    s_waitcnt lgkmcnt(10)
    v_mfma_f32_32x32x16_bf16 v[100:115], v[36:39], v[156:159], v[100:115]
    ds_read_b64_tr_b16 v[60:61], v19 offset:53248
    ds_read_b64_tr_b16 v[62:63], v19 offset:53760
    s_waitcnt lgkmcnt(10)
    v_mfma_f32_32x32x16_bf16 v[116:131], v[40:43], v[156:159], v[116:131]
    ds_read_b64_tr_b16 v[36:37], v20 offset:53248
    ds_read_b64_tr_b16 v[38:39], v20 offset:53760
    s_waitcnt lgkmcnt(10)
    v_mfma_f32_32x32x16_bf16 v[68:83], v[44:47], v[160:163], v[68:83]
    ds_read_b64_tr_b16 v[40:41], v21 offset:53248
    ds_read_b64_tr_b16 v[42:43], v21 offset:53760
    s_waitcnt lgkmcnt(10)
    v_mfma_f32_32x32x16_bf16 v[84:99], v[48:51], v[160:163], v[84:99]
    ds_read_b64_tr_b16 v[44:45], v22 offset:53248
    ds_read_b64_tr_b16 v[46:47], v22 offset:53760
    s_waitcnt lgkmcnt(10)
    v_mfma_f32_32x32x16_bf16 v[100:115], v[52:55], v[160:163], v[100:115]
    ds_read_b64_tr_b16 v[48:49], v19 offset:57344
    ds_read_b64_tr_b16 v[50:51], v19 offset:57856
    s_waitcnt lgkmcnt(10)
    v_mfma_f32_32x32x16_bf16 v[116:131], v[56:59], v[160:163], v[116:131]
    ds_read_b64_tr_b16 v[52:53], v20 offset:57344
    ds_read_b64_tr_b16 v[54:55], v20 offset:57856
    s_waitcnt lgkmcnt(10)
    v_mfma_f32_32x32x16_bf16 v[68:83], v[60:63], v[164:167], v[68:83]
    ds_read_b64_tr_b16 v[56:57], v21 offset:57344
    ds_read_b64_tr_b16 v[58:59], v21 offset:57856
    s_waitcnt lgkmcnt(10)
    v_mfma_f32_32x32x16_bf16 v[84:99], v[36:39], v[164:167], v[84:99]
    ds_read_b64_tr_b16 v[60:61], v22 offset:57344
    ds_read_b64_tr_b16 v[62:63], v22 offset:57856
    s_waitcnt lgkmcnt(10)
    v_mfma_f32_32x32x16_bf16 v[100:115], v[40:43], v[164:167], v[100:115]
    ds_read_b64_tr_b16 v[36:37], v19 offset:61440
    ds_read_b64_tr_b16 v[38:39], v19 offset:61952
    s_waitcnt lgkmcnt(10)
    v_mfma_f32_32x32x16_bf16 v[116:131], v[44:47], v[164:167], v[116:131]
    ds_read_b64_tr_b16 v[40:41], v20 offset:61440
    ds_read_b64_tr_b16 v[42:43], v20 offset:61952
    s_waitcnt lgkmcnt(10)
    v_mfma_f32_32x32x16_bf16 v[68:83], v[48:51], v[168:171], v[68:83]
    ds_read_b64_tr_b16 v[44:45], v21 offset:61440
    ds_read_b64_tr_b16 v[46:47], v21 offset:61952
    s_waitcnt lgkmcnt(10)
    v_mfma_f32_32x32x16_bf16 v[84:99], v[52:55], v[168:171], v[84:99]
    ds_read_b64_tr_b16 v[48:49], v22 offset:61440
    ds_read_b64_tr_b16 v[50:51], v22 offset:61952
    s_waitcnt lgkmcnt(10)
    v_mfma_f32_32x32x16_bf16 v[100:115], v[56:59], v[168:171], v[100:115]
    s_waitcnt vmcnt(13)
    s_barrier
    ds_read_b64_tr_b16 v[52:53], v15 offset:49152
    ds_read_b64_tr_b16 v[54:55], v15 offset:49664
    s_waitcnt lgkmcnt(10)
    v_mfma_f32_32x32x16_bf16 v[116:131], v[60:63], v[168:171], v[116:131]
    ds_read_b64_tr_b16 v[56:57], v16 offset:49152
    ds_read_b64_tr_b16 v[58:59], v16 offset:49664
    s_waitcnt lgkmcnt(10)
    v_mfma_f32_32x32x16_bf16 v[68:83], v[36:39], v[172:175], v[68:83]
    ds_read_b64_tr_b16 v[60:61], v17 offset:49152
    ds_read_b64_tr_b16 v[62:63], v17 offset:49664
    s_waitcnt lgkmcnt(10)
    v_mfma_f32_32x32x16_bf16 v[84:99], v[40:43], v[172:175], v[84:99]
    ds_read_b64_tr_b16 v[36:37], v18 offset:49152
    ds_read_b64_tr_b16 v[38:39], v18 offset:49664
    s_waitcnt lgkmcnt(10)
    v_mfma_f32_32x32x16_bf16 v[100:115], v[44:47], v[172:175], v[100:115]
    ds_read_b64_tr_b16 v[40:41], v15 offset:53248
    ds_read_b64_tr_b16 v[42:43], v15 offset:53760
    s_waitcnt lgkmcnt(10)
    v_mfma_f32_32x32x16_bf16 v[116:131], v[48:51], v[172:175], v[116:131]
    ds_read_b64_tr_b16 v[44:45], v16 offset:53248
    ds_read_b64_tr_b16 v[46:47], v16 offset:53760
    s_waitcnt lgkmcnt(10)
    v_mfma_f32_32x32x16_bf16 v[68:83], v[52:55], v[176:179], v[68:83]
    ds_read_b64_tr_b16 v[48:49], v17 offset:53248
    ds_read_b64_tr_b16 v[50:51], v17 offset:53760
    s_waitcnt lgkmcnt(10)
    v_mfma_f32_32x32x16_bf16 v[84:99], v[56:59], v[176:179], v[84:99]
    ds_read_b64_tr_b16 v[52:53], v18 offset:53248
    ds_read_b64_tr_b16 v[54:55], v18 offset:53760
    s_waitcnt lgkmcnt(10)
    v_mfma_f32_32x32x16_bf16 v[100:115], v[60:63], v[176:179], v[100:115]
    ds_read_b64_tr_b16 v[56:57], v15 offset:57344
    ds_read_b64_tr_b16 v[58:59], v15 offset:57856
    s_waitcnt lgkmcnt(10)
    v_mfma_f32_32x32x16_bf16 v[116:131], v[36:39], v[176:179], v[116:131]
    ds_read_b64_tr_b16 v[60:61], v16 offset:57344
    ds_read_b64_tr_b16 v[62:63], v16 offset:57856
    s_waitcnt lgkmcnt(10)
    v_mfma_f32_32x32x16_bf16 v[68:83], v[40:43], v[180:183], v[68:83]
    ds_read_b64_tr_b16 v[36:37], v17 offset:57344
    ds_read_b64_tr_b16 v[38:39], v17 offset:57856
    s_waitcnt lgkmcnt(10)
    v_mfma_f32_32x32x16_bf16 v[84:99], v[44:47], v[180:183], v[84:99]
    ds_read_b64_tr_b16 v[40:41], v18 offset:57344
    ds_read_b64_tr_b16 v[42:43], v18 offset:57856
    s_waitcnt lgkmcnt(10)
    v_mfma_f32_32x32x16_bf16 v[100:115], v[48:51], v[180:183], v[100:115]
    ds_read_b64_tr_b16 v[44:45], v15 offset:61440
    ds_read_b64_tr_b16 v[46:47], v15 offset:61952
    s_waitcnt lgkmcnt(10)
    v_mfma_f32_32x32x16_bf16 v[116:131], v[52:55], v[180:183], v[116:131]
    ds_read_b64_tr_b16 v[48:49], v16 offset:61440
    ds_read_b64_tr_b16 v[50:51], v16 offset:61952
    s_waitcnt lgkmcnt(10)
    v_mfma_f32_32x32x16_bf16 v[68:83], v[56:59], v[184:187], v[68:83]
    ds_read_b64_tr_b16 v[52:53], v17 offset:61440
    ds_read_b64_tr_b16 v[54:55], v17 offset:61952
    s_waitcnt lgkmcnt(10)
    v_mfma_f32_32x32x16_bf16 v[84:99], v[60:63], v[184:187], v[84:99]
    ds_read_b64_tr_b16 v[56:57], v18 offset:61440
    ds_read_b64_tr_b16 v[58:59], v18 offset:61952
    s_waitcnt lgkmcnt(10)
    v_mfma_f32_32x32x16_bf16 v[100:115], v[36:39], v[184:187], v[100:115]
    s_waitcnt vmcnt(9)
    s_barrier
    ds_read_b64_tr_b16 v[60:61], v23 offset:0
    ds_read_b64_tr_b16 v[62:63], v23 offset:512
    s_waitcnt lgkmcnt(10)
    v_mfma_f32_32x32x16_bf16 v[116:131], v[40:43], v[184:187], v[116:131]
    ds_read_b64_tr_b16 v[36:37], v24 offset:0
    ds_read_b64_tr_b16 v[38:39], v24 offset:512
    s_waitcnt lgkmcnt(10)
    v_mfma_f32_32x32x16_bf16 v[68:83], v[44:47], v[188:191], v[68:83]
    ds_read_b64_tr_b16 v[40:41], v25 offset:0
    ds_read_b64_tr_b16 v[42:43], v25 offset:512
    s_waitcnt lgkmcnt(10)
    v_mfma_f32_32x32x16_bf16 v[84:99], v[48:51], v[188:191], v[84:99]
    ds_read_b64_tr_b16 v[44:45], v26 offset:0
    ds_read_b64_tr_b16 v[46:47], v26 offset:512
    s_waitcnt lgkmcnt(10)
    v_mfma_f32_32x32x16_bf16 v[100:115], v[52:55], v[188:191], v[100:115]
    ds_read_b64_tr_b16 v[48:49], v23 offset:4096
    ds_read_b64_tr_b16 v[50:51], v23 offset:4608
    s_waitcnt lgkmcnt(10)
    v_mfma_f32_32x32x16_bf16 v[116:131], v[56:59], v[188:191], v[116:131]
    ds_read_b64_tr_b16 v[52:53], v24 offset:4096
    ds_read_b64_tr_b16 v[54:55], v24 offset:4608
    s_waitcnt lgkmcnt(10)
    v_mfma_f32_32x32x16_bf16 v[68:83], v[60:63], v[192:195], v[68:83]
    ds_read_b64_tr_b16 v[56:57], v25 offset:4096
    ds_read_b64_tr_b16 v[58:59], v25 offset:4608
    s_waitcnt lgkmcnt(10)
    v_mfma_f32_32x32x16_bf16 v[84:99], v[36:39], v[192:195], v[84:99]
    ds_read_b64_tr_b16 v[60:61], v26 offset:4096
    ds_read_b64_tr_b16 v[62:63], v26 offset:4608
    s_waitcnt lgkmcnt(10)
    v_mfma_f32_32x32x16_bf16 v[100:115], v[40:43], v[192:195], v[100:115]
    ds_read_b64_tr_b16 v[36:37], v23 offset:8192
    ds_read_b64_tr_b16 v[38:39], v23 offset:8704
    s_waitcnt lgkmcnt(10)
    v_mfma_f32_32x32x16_bf16 v[116:131], v[44:47], v[192:195], v[116:131]
    ds_read_b64_tr_b16 v[40:41], v24 offset:8192
    ds_read_b64_tr_b16 v[42:43], v24 offset:8704
    s_waitcnt lgkmcnt(10)
    v_mfma_f32_32x32x16_bf16 v[68:83], v[48:51], v[196:199], v[68:83]
    ds_read_b64_tr_b16 v[44:45], v25 offset:8192
    ds_read_b64_tr_b16 v[46:47], v25 offset:8704
    s_waitcnt lgkmcnt(10)
    v_mfma_f32_32x32x16_bf16 v[84:99], v[52:55], v[196:199], v[84:99]
    ds_read_b64_tr_b16 v[48:49], v26 offset:8192
    ds_read_b64_tr_b16 v[50:51], v26 offset:8704
    s_waitcnt lgkmcnt(10)
    v_mfma_f32_32x32x16_bf16 v[100:115], v[56:59], v[196:199], v[100:115]
    ds_read_b64_tr_b16 v[52:53], v23 offset:12288
    ds_read_b64_tr_b16 v[54:55], v23 offset:12800
    s_waitcnt lgkmcnt(10)
    v_mfma_f32_32x32x16_bf16 v[116:131], v[60:63], v[196:199], v[116:131]
    ds_read_b64_tr_b16 v[56:57], v24 offset:12288
    ds_read_b64_tr_b16 v[58:59], v24 offset:12800
    s_waitcnt lgkmcnt(10)
    v_mfma_f32_32x32x16_bf16 v[68:83], v[36:39], v[200:203], v[68:83]
    ds_read_b64_tr_b16 v[60:61], v25 offset:12288
    ds_read_b64_tr_b16 v[62:63], v25 offset:12800
    s_waitcnt lgkmcnt(10)
    v_mfma_f32_32x32x16_bf16 v[84:99], v[40:43], v[200:203], v[84:99]
    ds_read_b64_tr_b16 v[36:37], v26 offset:12288
    ds_read_b64_tr_b16 v[38:39], v26 offset:12800
    s_waitcnt lgkmcnt(10)
    v_mfma_f32_32x32x16_bf16 v[100:115], v[44:47], v[200:203], v[100:115]
    s_waitcnt vmcnt(4)
    s_barrier
    ds_read_b64_tr_b16 v[40:41], v19 offset:0
    ds_read_b64_tr_b16 v[42:43], v19 offset:512
    s_waitcnt lgkmcnt(10)
    v_mfma_f32_32x32x16_bf16 v[116:131], v[48:51], v[200:203], v[116:131]
    ds_read_b64_tr_b16 v[44:45], v20 offset:0
    ds_read_b64_tr_b16 v[46:47], v20 offset:512
    s_waitcnt lgkmcnt(10)
    v_mfma_f32_32x32x16_bf16 v[68:83], v[52:55], v[204:207], v[68:83]
    ds_read_b64_tr_b16 v[48:49], v21 offset:0
    ds_read_b64_tr_b16 v[50:51], v21 offset:512
    s_waitcnt lgkmcnt(10)
    v_mfma_f32_32x32x16_bf16 v[84:99], v[56:59], v[204:207], v[84:99]
    ds_read_b64_tr_b16 v[52:53], v22 offset:0
    ds_read_b64_tr_b16 v[54:55], v22 offset:512
    s_waitcnt lgkmcnt(10)
    v_mfma_f32_32x32x16_bf16 v[100:115], v[60:63], v[204:207], v[100:115]
    ds_read_b64_tr_b16 v[56:57], v19 offset:4096
    ds_read_b64_tr_b16 v[58:59], v19 offset:4608
    s_waitcnt lgkmcnt(10)
    v_mfma_f32_32x32x16_bf16 v[116:131], v[36:39], v[204:207], v[116:131]
    ds_read_b64_tr_b16 v[60:61], v20 offset:4096
    ds_read_b64_tr_b16 v[62:63], v20 offset:4608
    s_waitcnt lgkmcnt(10)
    v_mfma_f32_32x32x16_bf16 v[68:83], v[40:43], v[208:211], v[68:83]
    ds_read_b64_tr_b16 v[36:37], v21 offset:4096
    ds_read_b64_tr_b16 v[38:39], v21 offset:4608
    s_waitcnt lgkmcnt(10)
    v_mfma_f32_32x32x16_bf16 v[84:99], v[44:47], v[208:211], v[84:99]
    ds_read_b64_tr_b16 v[40:41], v22 offset:4096
    ds_read_b64_tr_b16 v[42:43], v22 offset:4608
    s_waitcnt lgkmcnt(10)
    v_mfma_f32_32x32x16_bf16 v[100:115], v[48:51], v[208:211], v[100:115]
    ds_read_b64_tr_b16 v[44:45], v19 offset:8192
    ds_read_b64_tr_b16 v[46:47], v19 offset:8704
    s_waitcnt lgkmcnt(10)
    v_mfma_f32_32x32x16_bf16 v[116:131], v[52:55], v[208:211], v[116:131]
    ds_read_b64_tr_b16 v[48:49], v20 offset:8192
    ds_read_b64_tr_b16 v[50:51], v20 offset:8704
    s_waitcnt lgkmcnt(10)
    v_mfma_f32_32x32x16_bf16 v[68:83], v[56:59], v[212:215], v[68:83]
    ds_read_b64_tr_b16 v[52:53], v21 offset:8192
    ds_read_b64_tr_b16 v[54:55], v21 offset:8704
    s_waitcnt lgkmcnt(10)
    v_mfma_f32_32x32x16_bf16 v[84:99], v[60:63], v[212:215], v[84:99]
    ds_read_b64_tr_b16 v[56:57], v22 offset:8192
    ds_read_b64_tr_b16 v[58:59], v22 offset:8704
    s_waitcnt lgkmcnt(10)
    v_mfma_f32_32x32x16_bf16 v[100:115], v[36:39], v[212:215], v[100:115]
    ds_read_b64_tr_b16 v[60:61], v19 offset:12288
    ds_read_b64_tr_b16 v[62:63], v19 offset:12800
    s_waitcnt lgkmcnt(10)
    v_mfma_f32_32x32x16_bf16 v[116:131], v[40:43], v[212:215], v[116:131]
    ds_read_b64_tr_b16 v[36:37], v20 offset:12288
    ds_read_b64_tr_b16 v[38:39], v20 offset:12800
    s_waitcnt lgkmcnt(10)
    v_mfma_f32_32x32x16_bf16 v[68:83], v[44:47], v[216:219], v[68:83]
    ds_read_b64_tr_b16 v[40:41], v21 offset:12288
    ds_read_b64_tr_b16 v[42:43], v21 offset:12800
    s_waitcnt lgkmcnt(10)
    v_mfma_f32_32x32x16_bf16 v[84:99], v[48:51], v[216:219], v[84:99]
    ds_read_b64_tr_b16 v[44:45], v22 offset:12288
    ds_read_b64_tr_b16 v[46:47], v22 offset:12800
    s_waitcnt lgkmcnt(10)
    v_mfma_f32_32x32x16_bf16 v[100:115], v[52:55], v[216:219], v[100:115]
    s_waitcnt vmcnt(0)
    s_barrier
    ds_read_b64_tr_b16 v[48:49], v23 offset:16384
    ds_read_b64_tr_b16 v[50:51], v23 offset:16896
    s_waitcnt lgkmcnt(10)
    v_mfma_f32_32x32x16_bf16 v[116:131], v[56:59], v[216:219], v[116:131]
    ds_read_b64_tr_b16 v[52:53], v24 offset:16384
    ds_read_b64_tr_b16 v[54:55], v24 offset:16896
    s_waitcnt lgkmcnt(10)
    v_mfma_f32_32x32x16_bf16 v[68:83], v[60:63], v[220:223], v[68:83]
    ds_read_b64_tr_b16 v[56:57], v25 offset:16384
    ds_read_b64_tr_b16 v[58:59], v25 offset:16896
    s_waitcnt lgkmcnt(10)
    v_mfma_f32_32x32x16_bf16 v[84:99], v[36:39], v[220:223], v[84:99]
    ds_read_b64_tr_b16 v[60:61], v26 offset:16384
    ds_read_b64_tr_b16 v[62:63], v26 offset:16896
    s_waitcnt lgkmcnt(10)
    v_mfma_f32_32x32x16_bf16 v[100:115], v[40:43], v[220:223], v[100:115]
    ds_read_b64_tr_b16 v[36:37], v23 offset:20480
    ds_read_b64_tr_b16 v[38:39], v23 offset:20992
    s_waitcnt lgkmcnt(10)
    v_mfma_f32_32x32x16_bf16 v[116:131], v[44:47], v[220:223], v[116:131]
    ds_read_b64_tr_b16 v[40:41], v24 offset:20480
    ds_read_b64_tr_b16 v[42:43], v24 offset:20992
    s_waitcnt lgkmcnt(10)
    v_mfma_f32_32x32x16_bf16 v[68:83], v[48:51], v[224:227], v[68:83]
    ds_read_b64_tr_b16 v[44:45], v25 offset:20480
    ds_read_b64_tr_b16 v[46:47], v25 offset:20992
    s_waitcnt lgkmcnt(10)
    v_mfma_f32_32x32x16_bf16 v[84:99], v[52:55], v[224:227], v[84:99]
    ds_read_b64_tr_b16 v[48:49], v26 offset:20480
    ds_read_b64_tr_b16 v[50:51], v26 offset:20992
    s_waitcnt lgkmcnt(10)
    v_mfma_f32_32x32x16_bf16 v[100:115], v[56:59], v[224:227], v[100:115]
    ds_read_b64_tr_b16 v[52:53], v23 offset:24576
    ds_read_b64_tr_b16 v[54:55], v23 offset:25088
    s_waitcnt lgkmcnt(10)
    v_mfma_f32_32x32x16_bf16 v[116:131], v[60:63], v[224:227], v[116:131]
    ds_read_b64_tr_b16 v[56:57], v24 offset:24576
    ds_read_b64_tr_b16 v[58:59], v24 offset:25088
    s_waitcnt lgkmcnt(10)
    v_mfma_f32_32x32x16_bf16 v[68:83], v[36:39], v[228:231], v[68:83]
    ds_read_b64_tr_b16 v[60:61], v25 offset:24576
    ds_read_b64_tr_b16 v[62:63], v25 offset:25088
    s_waitcnt lgkmcnt(10)
    v_mfma_f32_32x32x16_bf16 v[84:99], v[40:43], v[228:231], v[84:99]
    ds_read_b64_tr_b16 v[36:37], v26 offset:24576
    ds_read_b64_tr_b16 v[38:39], v26 offset:25088
    s_waitcnt lgkmcnt(10)
    v_mfma_f32_32x32x16_bf16 v[100:115], v[44:47], v[228:231], v[100:115]
    ds_read_b64_tr_b16 v[40:41], v23 offset:28672
    ds_read_b64_tr_b16 v[42:43], v23 offset:29184
    s_waitcnt lgkmcnt(10)
    v_mfma_f32_32x32x16_bf16 v[116:131], v[48:51], v[228:231], v[116:131]
    ds_read_b64_tr_b16 v[44:45], v24 offset:28672
    ds_read_b64_tr_b16 v[46:47], v24 offset:29184
    s_waitcnt lgkmcnt(10)
    v_mfma_f32_32x32x16_bf16 v[68:83], v[52:55], v[232:235], v[68:83]
    ds_read_b64_tr_b16 v[48:49], v25 offset:28672
    ds_read_b64_tr_b16 v[50:51], v25 offset:29184
    s_waitcnt lgkmcnt(10)
    v_mfma_f32_32x32x16_bf16 v[84:99], v[56:59], v[232:235], v[84:99]
    ds_read_b64_tr_b16 v[52:53], v26 offset:28672
    ds_read_b64_tr_b16 v[54:55], v26 offset:29184
    s_waitcnt lgkmcnt(10)
    v_mfma_f32_32x32x16_bf16 v[100:115], v[60:63], v[232:235], v[100:115]
    s_barrier
    ds_read_b64_tr_b16 v[56:57], v15 offset:0
    ds_read_b64_tr_b16 v[58:59], v15 offset:512
    s_waitcnt lgkmcnt(10)
    v_mfma_f32_32x32x16_bf16 v[116:131], v[36:39], v[232:235], v[116:131]
    ds_read_b64_tr_b16 v[60:61], v16 offset:0
    ds_read_b64_tr_b16 v[62:63], v16 offset:512
    s_waitcnt lgkmcnt(10)
    v_mfma_f32_32x32x16_bf16 v[68:83], v[40:43], v[236:239], v[68:83]
    ds_read_b64_tr_b16 v[36:37], v17 offset:0
    ds_read_b64_tr_b16 v[38:39], v17 offset:512
    s_waitcnt lgkmcnt(10)
    v_mfma_f32_32x32x16_bf16 v[84:99], v[44:47], v[236:239], v[84:99]
    ds_read_b64_tr_b16 v[40:41], v18 offset:0
    ds_read_b64_tr_b16 v[42:43], v18 offset:512
    s_waitcnt lgkmcnt(10)
    v_mfma_f32_32x32x16_bf16 v[100:115], v[48:51], v[236:239], v[100:115]
    ds_read_b64_tr_b16 v[44:45], v15 offset:4096
    ds_read_b64_tr_b16 v[46:47], v15 offset:4608
    s_waitcnt lgkmcnt(10)
    v_mfma_f32_32x32x16_bf16 v[116:131], v[52:55], v[236:239], v[116:131]
    ds_read_b64_tr_b16 v[48:49], v16 offset:4096
    ds_read_b64_tr_b16 v[50:51], v16 offset:4608
    s_waitcnt lgkmcnt(10)
    v_mfma_f32_32x32x16_bf16 v[68:83], v[56:59], v[240:243], v[68:83]
    ds_read_b64_tr_b16 v[52:53], v17 offset:4096
    ds_read_b64_tr_b16 v[54:55], v17 offset:4608
    s_waitcnt lgkmcnt(10)
    v_mfma_f32_32x32x16_bf16 v[84:99], v[60:63], v[240:243], v[84:99]
    ds_read_b64_tr_b16 v[56:57], v18 offset:4096
    ds_read_b64_tr_b16 v[58:59], v18 offset:4608
    s_waitcnt lgkmcnt(10)
    v_mfma_f32_32x32x16_bf16 v[100:115], v[36:39], v[240:243], v[100:115]
    ds_read_b64_tr_b16 v[60:61], v15 offset:8192
    ds_read_b64_tr_b16 v[62:63], v15 offset:8704
    s_waitcnt lgkmcnt(10)
    v_mfma_f32_32x32x16_bf16 v[116:131], v[40:43], v[240:243], v[116:131]
    ds_read_b64_tr_b16 v[36:37], v16 offset:8192
    ds_read_b64_tr_b16 v[38:39], v16 offset:8704
    s_waitcnt lgkmcnt(10)
    v_mfma_f32_32x32x16_bf16 v[68:83], v[44:47], v[244:247], v[68:83]
    ds_read_b64_tr_b16 v[40:41], v17 offset:8192
    ds_read_b64_tr_b16 v[42:43], v17 offset:8704
    s_waitcnt lgkmcnt(10)
    v_mfma_f32_32x32x16_bf16 v[84:99], v[48:51], v[244:247], v[84:99]
    ds_read_b64_tr_b16 v[44:45], v18 offset:8192
    ds_read_b64_tr_b16 v[46:47], v18 offset:8704
    s_waitcnt lgkmcnt(10)
    v_mfma_f32_32x32x16_bf16 v[100:115], v[52:55], v[244:247], v[100:115]
    ds_read_b64_tr_b16 v[48:49], v15 offset:12288
    ds_read_b64_tr_b16 v[50:51], v15 offset:12800
    s_waitcnt lgkmcnt(10)
    v_mfma_f32_32x32x16_bf16 v[116:131], v[56:59], v[244:247], v[116:131]
    ds_read_b64_tr_b16 v[52:53], v16 offset:12288
    ds_read_b64_tr_b16 v[54:55], v16 offset:12800
    s_waitcnt lgkmcnt(10)
    v_mfma_f32_32x32x16_bf16 v[68:83], v[60:63], v[248:251], v[68:83]
    ds_read_b64_tr_b16 v[56:57], v17 offset:12288
    ds_read_b64_tr_b16 v[58:59], v17 offset:12800
    s_waitcnt lgkmcnt(10)
    v_mfma_f32_32x32x16_bf16 v[84:99], v[36:39], v[248:251], v[84:99]
    ds_read_b64_tr_b16 v[60:61], v18 offset:12288
    ds_read_b64_tr_b16 v[62:63], v18 offset:12800
    s_waitcnt lgkmcnt(10)
    v_mfma_f32_32x32x16_bf16 v[100:115], v[40:43], v[248:251], v[100:115]
    s_waitcnt lgkmcnt(8)
    v_mfma_f32_32x32x16_bf16 v[116:131], v[44:47], v[248:251], v[116:131]
    s_waitcnt lgkmcnt(6)
    v_mfma_f32_32x32x16_bf16 v[68:83], v[48:51], v[252:255], v[68:83]
    s_waitcnt lgkmcnt(4)
    v_mfma_f32_32x32x16_bf16 v[84:99], v[52:55], v[252:255], v[84:99]
    s_waitcnt lgkmcnt(2)
    v_mfma_f32_32x32x16_bf16 v[100:115], v[56:59], v[252:255], v[100:115]
    s_waitcnt lgkmcnt(0)
    v_mfma_f32_32x32x16_bf16 v[116:131], v[60:63], v[252:255], v[116:131]
    s_barrier
    s_setprio 1
    v_mov_b32 v22, 0xbdd2d3e8
    v_mov_b32 v23, 0xbdd2d3e8
    v_mov_b32 v24, 0xc0135761
    v_mov_b32 v25, 0xc0135761
    v_mov_b32 v26, 0x3f800000
    v_mov_b32 v27, 0x3f800000
    v_mov_b32 v15, v35
    v_xor_b32 v16, 64, v35
    v_add_u32 v17, 0x10000, v35
    v_xor_b32 v18, 64, v17
    v_add_u32 v19, 0x20000, v35
    v_xor_b32 v20, 64, v19
    s_nop 1
    v_pk_mul_f32 v[36:37], v[68:69], v[68:69]
    v_pk_mul_f32 v[38:39], v[70:71], v[70:71]
    v_pk_mul_f32 v[40:41], v[72:73], v[72:73]
    v_pk_mul_f32 v[42:43], v[74:75], v[74:75]
    v_pk_fma_f32 v[36:37], v[36:37], v[22:23], v[24:25]
    v_pk_fma_f32 v[38:39], v[38:39], v[22:23], v[24:25]
    v_pk_fma_f32 v[40:41], v[40:41], v[22:23], v[24:25]
    v_pk_fma_f32 v[42:43], v[42:43], v[22:23], v[24:25]
    v_pk_mul_f32 v[36:37], v[68:69], v[36:37]
    v_pk_mul_f32 v[38:39], v[70:71], v[38:39]
    v_pk_mul_f32 v[40:41], v[72:73], v[40:41]
    v_pk_mul_f32 v[42:43], v[74:75], v[42:43]
    v_exp_f32 v36, v36
    v_exp_f32 v37, v37
    v_exp_f32 v38, v38
    v_exp_f32 v39, v39
    v_exp_f32 v40, v40
    v_exp_f32 v41, v41
    v_exp_f32 v42, v42
    v_exp_f32 v43, v43
    v_pk_mul_f32 v[68:69], v[68:69], v[76:77]
    v_pk_mul_f32 v[70:71], v[70:71], v[78:79]
    v_pk_mul_f32 v[72:73], v[72:73], v[80:81]
    v_pk_mul_f32 v[74:75], v[74:75], v[82:83]
    v_pk_add_f32 v[36:37], v[36:37], v[26:27]
    v_pk_add_f32 v[38:39], v[38:39], v[26:27]
    v_pk_add_f32 v[40:41], v[40:41], v[26:27]
    v_pk_add_f32 v[42:43], v[42:43], v[26:27]
    v_rcp_f32 v36, v36
    v_rcp_f32 v37, v37
    v_rcp_f32 v38, v38
    v_rcp_f32 v39, v39
    v_rcp_f32 v40, v40
    v_rcp_f32 v41, v41
    v_rcp_f32 v42, v42
    v_rcp_f32 v43, v43
    v_pk_mul_f32 v[36:37], v[68:69], v[36:37]
    v_pk_mul_f32 v[38:39], v[70:71], v[38:39]
    v_pk_mul_f32 v[40:41], v[72:73], v[40:41]
    v_pk_mul_f32 v[42:43], v[74:75], v[42:43]
    v_cvt_pk_bf16_f32 v44, v36, v37
    v_cvt_pk_bf16_f32 v45, v38, v39
    v_cvt_pk_bf16_f32 v46, v40, v41
    v_cvt_pk_bf16_f32 v47, v42, v43
    s_add_u32 s57, s53, 0
    buffer_store_dwordx4 v[44:47], v9, s[32:35], s57 offen sc1
    v_pk_mul_f32 v[48:49], v[84:85], v[84:85]
    v_pk_mul_f32 v[50:51], v[86:87], v[86:87]
    v_pk_mul_f32 v[52:53], v[88:89], v[88:89]
    v_pk_mul_f32 v[54:55], v[90:91], v[90:91]
    v_pk_fma_f32 v[48:49], v[48:49], v[22:23], v[24:25]
    v_pk_fma_f32 v[50:51], v[50:51], v[22:23], v[24:25]
    v_pk_fma_f32 v[52:53], v[52:53], v[22:23], v[24:25]
    v_pk_fma_f32 v[54:55], v[54:55], v[22:23], v[24:25]
    v_pk_mul_f32 v[48:49], v[84:85], v[48:49]
    v_pk_mul_f32 v[50:51], v[86:87], v[50:51]
    v_pk_mul_f32 v[52:53], v[88:89], v[52:53]
    v_pk_mul_f32 v[54:55], v[90:91], v[54:55]
    v_exp_f32 v48, v48
    v_exp_f32 v49, v49
    v_exp_f32 v50, v50
    v_exp_f32 v51, v51
    v_exp_f32 v52, v52
    v_exp_f32 v53, v53
    v_exp_f32 v54, v54
    v_exp_f32 v55, v55
    v_pk_mul_f32 v[84:85], v[84:85], v[92:93]
    v_pk_mul_f32 v[86:87], v[86:87], v[94:95]
    v_pk_mul_f32 v[88:89], v[88:89], v[96:97]
    v_pk_mul_f32 v[90:91], v[90:91], v[98:99]
    v_pk_add_f32 v[48:49], v[48:49], v[26:27]
    v_pk_add_f32 v[50:51], v[50:51], v[26:27]
    v_pk_add_f32 v[52:53], v[52:53], v[26:27]
    v_pk_add_f32 v[54:55], v[54:55], v[26:27]
    v_rcp_f32 v48, v48
    v_rcp_f32 v49, v49
    v_rcp_f32 v50, v50
    v_rcp_f32 v51, v51
    v_rcp_f32 v52, v52
    v_rcp_f32 v53, v53
    v_rcp_f32 v54, v54
    v_rcp_f32 v55, v55
    v_pk_mul_f32 v[48:49], v[84:85], v[48:49]
    v_pk_mul_f32 v[50:51], v[86:87], v[50:51]
    v_pk_mul_f32 v[52:53], v[88:89], v[52:53]
    v_pk_mul_f32 v[54:55], v[90:91], v[54:55]
    v_cvt_pk_bf16_f32 v56, v48, v49
    v_cvt_pk_bf16_f32 v57, v50, v51
    v_cvt_pk_bf16_f32 v58, v52, v53
    v_cvt_pk_bf16_f32 v59, v54, v55
    s_add_u32 s57, s53, 1024
    buffer_store_dwordx4 v[56:59], v9, s[32:35], s57 offen sc1
    v_pk_mul_f32 v[36:37], v[100:101], v[100:101]
    v_pk_mul_f32 v[38:39], v[102:103], v[102:103]
    v_pk_mul_f32 v[40:41], v[104:105], v[104:105]
    v_pk_mul_f32 v[42:43], v[106:107], v[106:107]
    v_pk_fma_f32 v[36:37], v[36:37], v[22:23], v[24:25]
    v_pk_fma_f32 v[38:39], v[38:39], v[22:23], v[24:25]
    v_pk_fma_f32 v[40:41], v[40:41], v[22:23], v[24:25]
    v_pk_fma_f32 v[42:43], v[42:43], v[22:23], v[24:25]
    v_pk_mul_f32 v[36:37], v[100:101], v[36:37]
    v_pk_mul_f32 v[38:39], v[102:103], v[38:39]
    v_pk_mul_f32 v[40:41], v[104:105], v[40:41]
    v_pk_mul_f32 v[42:43], v[106:107], v[42:43]
    v_exp_f32 v36, v36
    v_exp_f32 v37, v37
    v_exp_f32 v38, v38
    v_exp_f32 v39, v39
    v_exp_f32 v40, v40
    v_exp_f32 v41, v41
    v_exp_f32 v42, v42
    v_exp_f32 v43, v43
    v_pk_mul_f32 v[100:101], v[100:101], v[108:109]
    v_pk_mul_f32 v[102:103], v[102:103], v[110:111]
    v_pk_mul_f32 v[104:105], v[104:105], v[112:113]
    v_pk_mul_f32 v[106:107], v[106:107], v[114:115]
    v_pk_add_f32 v[36:37], v[36:37], v[26:27]
    v_pk_add_f32 v[38:39], v[38:39], v[26:27]
    v_pk_add_f32 v[40:41], v[40:41], v[26:27]
    v_pk_add_f32 v[42:43], v[42:43], v[26:27]
    v_rcp_f32 v36, v36
    v_rcp_f32 v37, v37
    v_rcp_f32 v38, v38
    v_rcp_f32 v39, v39
    v_rcp_f32 v40, v40
    v_rcp_f32 v41, v41
    v_rcp_f32 v42, v42
    v_rcp_f32 v43, v43
    v_pk_mul_f32 v[36:37], v[100:101], v[36:37]
    v_pk_mul_f32 v[38:39], v[102:103], v[38:39]
    v_pk_mul_f32 v[40:41], v[104:105], v[40:41]
    v_pk_mul_f32 v[42:43], v[106:107], v[42:43]
    v_cvt_pk_bf16_f32 v44, v36, v37
    v_cvt_pk_bf16_f32 v45, v38, v39
    v_cvt_pk_bf16_f32 v46, v40, v41
    v_cvt_pk_bf16_f32 v47, v42, v43
    s_add_u32 s57, s53, 2048
    buffer_store_dwordx4 v[44:47], v9, s[32:35], s57 offen sc1
    v_pk_mul_f32 v[48:49], v[116:117], v[116:117]
    v_pk_mul_f32 v[50:51], v[118:119], v[118:119]
    v_pk_mul_f32 v[52:53], v[120:121], v[120:121]
    v_pk_mul_f32 v[54:55], v[122:123], v[122:123]
    v_pk_fma_f32 v[48:49], v[48:49], v[22:23], v[24:25]
    v_pk_fma_f32 v[50:51], v[50:51], v[22:23], v[24:25]
    v_pk_fma_f32 v[52:53], v[52:53], v[22:23], v[24:25]
    v_pk_fma_f32 v[54:55], v[54:55], v[22:23], v[24:25]
    v_pk_mul_f32 v[48:49], v[116:117], v[48:49]
    v_pk_mul_f32 v[50:51], v[118:119], v[50:51]
    v_pk_mul_f32 v[52:53], v[120:121], v[52:53]
    v_pk_mul_f32 v[54:55], v[122:123], v[54:55]
    v_exp_f32 v48, v48
    v_exp_f32 v49, v49
    v_exp_f32 v50, v50
    v_exp_f32 v51, v51
    v_exp_f32 v52, v52
    v_exp_f32 v53, v53
    v_exp_f32 v54, v54
    v_exp_f32 v55, v55
    v_pk_mul_f32 v[116:117], v[116:117], v[124:125]
    v_pk_mul_f32 v[118:119], v[118:119], v[126:127]
    v_pk_mul_f32 v[120:121], v[120:121], v[128:129]
    v_pk_mul_f32 v[122:123], v[122:123], v[130:131]
    v_pk_add_f32 v[48:49], v[48:49], v[26:27]
    v_pk_add_f32 v[50:51], v[50:51], v[26:27]
    v_pk_add_f32 v[52:53], v[52:53], v[26:27]
    v_pk_add_f32 v[54:55], v[54:55], v[26:27]
    v_rcp_f32 v48, v48
    v_rcp_f32 v49, v49
    v_rcp_f32 v50, v50
    v_rcp_f32 v51, v51
    v_rcp_f32 v52, v52
    v_rcp_f32 v53, v53
    v_rcp_f32 v54, v54
    v_rcp_f32 v55, v55
    v_pk_mul_f32 v[48:49], v[116:117], v[48:49]
    v_pk_mul_f32 v[50:51], v[118:119], v[50:51]
    v_pk_mul_f32 v[52:53], v[120:121], v[52:53]
    v_pk_mul_f32 v[54:55], v[122:123], v[54:55]
    v_cvt_pk_bf16_f32 v56, v48, v49
    v_cvt_pk_bf16_f32 v57, v50, v51
    v_cvt_pk_bf16_f32 v58, v52, v53
    v_cvt_pk_bf16_f32 v59, v54, v55
    s_add_u32 s57, s53, 3072
    buffer_store_dwordx4 v[56:59], v9, s[32:35], s57 offen sc1
    s_add_u32 s55, s52, 131072
    v_add_u32 v132, s55, v9
    s_xor_b32 s55, s52, 8192
    s_add_u32 s55, s55, 131072
    v_add_u32 v133, s55, v9
    s_lshl_b32 s55, s62, 13
    s_lshl_b32 s56, s63, 12
    s_add_u32 s55, s55, s56
    s_add_u32 s56, s55, 114688
    v_add_u32 v134, s56, v9
    s_add_u32 s56, s55, 49152
    v_add_u32 v135, s56, v9
    v_and_b32 v136, 31, v0
    v_mul_u32_u24 v136, 896, v136
    v_lshrrev_b32 v137, 5, v0
    v_lshl_add_u32 v136, v137, 4, v136
    s_lshl_b32 s56, s48, 6
    s_lshl_b32 s55, s62, 5
    s_add_u32 s56, s56, s55
    s_mul_i32 s56, s56, 896
    s_lshl_b32 s55, s49, 7
    s_add_u32 s56, s56, s55
    s_lshl_b32 s55, s63, 6
    s_add_u32 s56, s56, s55
    v_readfirstlane_b32 s61, v13
    s_cmp_lg_u32 s61, 0
    s_cbranch_scc1 L_nok_6
L_nlp_7:
    s_sleep 2
    global_load_dword v13, v14, s[14:15] sc1
    s_waitcnt vmcnt(0)
    v_readfirstlane_b32 s61, v13
    s_cmp_eq_u32 s61, 0
    s_cbranch_scc1 L_nlp_7
L_nok_6:
    v_mov_b32 v14, s61
    s_waitcnt vmcnt(0)
    s_mov_b64 exec, 1
    global_store_dword v11, v14, s[16:17] offset:128 sc0 sc1
    s_mov_b64 exec, -1
    s_setprio 0
    s_mov_b64 exec, 0x7f
    global_load_dword v13, v12, s[16:17] offset:128 sc1
    s_mov_b64 exec, -1
    s_waitcnt vmcnt(0)
    s_mov_b64 exec, 0x7f
    v_cmp_ne_u32 vcc, s61, v13
    s_cbranch_vccz L_pok_8
L_plp_9:
    s_sleep 2
    global_load_dword v13, v12, s[16:17] offset:128 sc1
    s_waitcnt vmcnt(0)
    v_cmp_ne_u32 vcc, s61, v13
    s_cbranch_vccnz L_plp_9
L_pok_8:
    s_mov_b64 exec, -1
    s_lshl_b32 s57, s64, 14
    s_add_u32 s57, s57, s60
    buffer_load_dwordx4 v[144:147], v9, s[32:35], s57 offen offset:0 sc1
    s_lshl_b32 s57, s64, 14
    s_add_u32 s57, s57, s60
    buffer_load_dwordx4 v[148:151], v9, s[32:35], s57 offen offset:1024 sc1
    s_lshl_b32 s57, s64, 14
    s_add_u32 s57, s57, s60
    buffer_load_dwordx4 v[152:155], v9, s[32:35], s57 offen offset:2048 sc1
    s_lshl_b32 s57, s64, 14
    s_add_u32 s57, s57, s60
    buffer_load_dwordx4 v[156:159], v9, s[32:35], s57 offen offset:3072 sc1
    s_lshl_b32 s57, s65, 14
    s_add_u32 s57, s57, s60
    buffer_load_dwordx4 v[160:163], v9, s[32:35], s57 offen offset:0 sc1
    s_lshl_b32 s57, s65, 14
    s_add_u32 s57, s57, s60
    buffer_load_dwordx4 v[164:167], v9, s[32:35], s57 offen offset:1024 sc1
    s_barrier
    s_lshl_b32 s57, s65, 14
    s_add_u32 s57, s57, s60
    buffer_load_dwordx4 v[168:171], v9, s[32:35], s57 offen offset:2048 sc1
    s_lshl_b32 s57, s65, 14
    s_add_u32 s57, s57, s60
    buffer_load_dwordx4 v[172:175], v9, s[32:35], s57 offen offset:3072 sc1
    s_lshl_b32 s57, s66, 14
    s_add_u32 s57, s57, s60
    buffer_load_dwordx4 v[176:179], v9, s[32:35], s57 offen offset:0 sc1
    s_lshl_b32 s57, s66, 14
    s_add_u32 s57, s57, s60
    buffer_load_dwordx4 v[180:183], v9, s[32:35], s57 offen offset:1024 sc1
    s_lshl_b32 s57, s66, 14
    s_add_u32 s57, s57, s60
    buffer_load_dwordx4 v[184:187], v9, s[32:35], s57 offen offset:2048 sc1
    s_lshl_b32 s57, s66, 14
    s_add_u32 s57, s57, s60
    buffer_load_dwordx4 v[188:191], v9, s[32:35], s57 offen offset:3072 sc1
    s_lshl_b32 s57, s67, 14
    s_add_u32 s57, s57, s60
    buffer_load_dwordx4 v[192:195], v9, s[32:35], s57 offen offset:0 sc1
    s_lshl_b32 s57, s67, 14
    s_add_u32 s57, s57, s60
    buffer_load_dwordx4 v[196:199], v9, s[32:35], s57 offen offset:1024 sc1
    ds_read_b64_tr_b16 v[36:37], v17 offset:0
    ds_read_b64_tr_b16 v[38:39], v17 offset:1024
    ds_read_b64_tr_b16 v[40:41], v18 offset:0
    ds_read_b64_tr_b16 v[42:43], v18 offset:1024
    ds_read_b64_tr_b16 v[44:45], v17 offset:2048
    ds_read_b64_tr_b16 v[46:47], v17 offset:3072
    ds_read_b64_tr_b16 v[48:49], v18 offset:2048
    ds_read_b64_tr_b16 v[50:51], v18 offset:3072
    ds_read_b64_tr_b16 v[52:53], v17 offset:4096
    ds_read_b64_tr_b16 v[54:55], v17 offset:5120
    ds_read_b64_tr_b16 v[56:57], v18 offset:4096
    ds_read_b64_tr_b16 v[58:59], v18 offset:5120
    s_lshl_b32 s57, s67, 14
    s_add_u32 s57, s57, s60
    buffer_load_dwordx4 v[200:203], v9, s[32:35], s57 offen offset:2048 sc1
    s_waitcnt vmcnt(14)
    s_waitcnt lgkmcnt(8)
    v_mfma_f32_32x32x16_bf16 v[68:83], v[36:39], v[144:147], 0
    v_mfma_f32_32x32x16_bf16 v[84:99], v[40:43], v[144:147], 0
    ds_read_b64_tr_b16 v[60:61], v17 offset:6144
    ds_read_b64_tr_b16 v[62:63], v17 offset:7168
    ds_read_b64_tr_b16 v[64:65], v18 offset:6144
    ds_read_b64_tr_b16 v[66:67], v18 offset:7168
    s_lshl_b32 s57, s67, 14
    s_add_u32 s57, s57, s60
    buffer_load_dwordx4 v[204:207], v9, s[32:35], s57 offen offset:3072 sc1
    s_waitcnt vmcnt(14)
    s_waitcnt lgkmcnt(8)
    v_mfma_f32_32x32x16_bf16 v[68:83], v[44:47], v[148:151], v[68:83]
    v_mfma_f32_32x32x16_bf16 v[84:99], v[48:51], v[148:151], v[84:99]
    ds_read_b64_tr_b16 v[36:37], v17 offset:16384
    ds_read_b64_tr_b16 v[38:39], v17 offset:17408
    ds_read_b64_tr_b16 v[40:41], v18 offset:16384
    ds_read_b64_tr_b16 v[42:43], v18 offset:17408
    s_lshl_b32 s57, s68, 14
    s_add_u32 s57, s57, s60
    buffer_load_dwordx4 v[208:211], v9, s[32:35], s57 offen offset:0 sc1
    s_waitcnt vmcnt(14)
    s_waitcnt lgkmcnt(8)
    v_mfma_f32_32x32x16_bf16 v[68:83], v[52:55], v[152:155], v[68:83]
    v_mfma_f32_32x32x16_bf16 v[84:99], v[56:59], v[152:155], v[84:99]
    ds_read_b64_tr_b16 v[44:45], v17 offset:18432
    ds_read_b64_tr_b16 v[46:47], v17 offset:19456
    ds_read_b64_tr_b16 v[48:49], v18 offset:18432
    ds_read_b64_tr_b16 v[50:51], v18 offset:19456
    s_lshl_b32 s57, s68, 14
    s_add_u32 s57, s57, s60
    buffer_load_dwordx4 v[212:215], v9, s[32:35], s57 offen offset:1024 sc1
    s_waitcnt vmcnt(14)
    s_waitcnt lgkmcnt(8)
    v_mfma_f32_32x32x16_bf16 v[68:83], v[60:63], v[156:159], v[68:83]
    v_mfma_f32_32x32x16_bf16 v[84:99], v[64:67], v[156:159], v[84:99]
    ds_read_b64_tr_b16 v[52:53], v17 offset:20480
    ds_read_b64_tr_b16 v[54:55], v17 offset:21504
    ds_read_b64_tr_b16 v[56:57], v18 offset:20480
    ds_read_b64_tr_b16 v[58:59], v18 offset:21504
    s_lshl_b32 s57, s68, 14
    s_add_u32 s57, s57, s60
    buffer_load_dwordx4 v[216:219], v9, s[32:35], s57 offen offset:2048 sc1
    s_waitcnt vmcnt(14)
    s_waitcnt lgkmcnt(8)
    v_mfma_f32_32x32x16_bf16 v[68:83], v[36:39], v[160:163], v[68:83]
    v_mfma_f32_32x32x16_bf16 v[84:99], v[40:43], v[160:163], v[84:99]
    ds_read_b64_tr_b16 v[60:61], v17 offset:22528
    ds_read_b64_tr_b16 v[62:63], v17 offset:23552
    ds_read_b64_tr_b16 v[64:65], v18 offset:22528
    ds_read_b64_tr_b16 v[66:67], v18 offset:23552
    s_lshl_b32 s57, s68, 14
    s_add_u32 s57, s57, s60
    buffer_load_dwordx4 v[220:223], v9, s[32:35], s57 offen offset:3072 sc1
    s_waitcnt vmcnt(14)
    s_waitcnt lgkmcnt(8)
    v_mfma_f32_32x32x16_bf16 v[68:83], v[44:47], v[164:167], v[68:83]
    v_mfma_f32_32x32x16_bf16 v[84:99], v[48:51], v[164:167], v[84:99]
    ds_read_b64_tr_b16 v[36:37], v15 offset:16384
    ds_read_b64_tr_b16 v[38:39], v15 offset:17408
    ds_read_b64_tr_b16 v[40:41], v16 offset:16384
    ds_read_b64_tr_b16 v[42:43], v16 offset:17408
    s_lshl_b32 s57, s69, 14
    s_add_u32 s57, s57, s60
    buffer_load_dwordx4 v[224:227], v9, s[32:35], s57 offen offset:0 sc1
    s_waitcnt vmcnt(14)
    s_waitcnt lgkmcnt(8)
    v_mfma_f32_32x32x16_bf16 v[68:83], v[52:55], v[168:171], v[68:83]
    v_mfma_f32_32x32x16_bf16 v[84:99], v[56:59], v[168:171], v[84:99]
    ds_read_b64_tr_b16 v[44:45], v15 offset:18432
    ds_read_b64_tr_b16 v[46:47], v15 offset:19456
    ds_read_b64_tr_b16 v[48:49], v16 offset:18432
    ds_read_b64_tr_b16 v[50:51], v16 offset:19456
    s_lshl_b32 s57, s69, 14
    s_add_u32 s57, s57, s60
    buffer_load_dwordx4 v[228:231], v9, s[32:35], s57 offen offset:1024 sc1
    s_waitcnt vmcnt(14)
    s_waitcnt lgkmcnt(8)
    v_mfma_f32_32x32x16_bf16 v[68:83], v[60:63], v[172:175], v[68:83]
    v_mfma_f32_32x32x16_bf16 v[84:99], v[64:67], v[172:175], v[84:99]
    ds_read_b64_tr_b16 v[52:53], v15 offset:20480
    ds_read_b64_tr_b16 v[54:55], v15 offset:21504
    ds_read_b64_tr_b16 v[56:57], v16 offset:20480
    ds_read_b64_tr_b16 v[58:59], v16 offset:21504
    s_lshl_b32 s57, s69, 14
    s_add_u32 s57, s57, s60
    buffer_load_dwordx4 v[232:235], v9, s[32:35], s57 offen offset:2048 sc1
    s_waitcnt vmcnt(14)
    s_waitcnt lgkmcnt(8)
    v_mfma_f32_32x32x16_bf16 v[68:83], v[36:39], v[176:179], v[68:83]
    v_mfma_f32_32x32x16_bf16 v[84:99], v[40:43], v[176:179], v[84:99]
    ds_read_b64_tr_b16 v[60:61], v15 offset:22528
    ds_read_b64_tr_b16 v[62:63], v15 offset:23552
    ds_read_b64_tr_b16 v[64:65], v16 offset:22528
    ds_read_b64_tr_b16 v[66:67], v16 offset:23552
    s_lshl_b32 s57, s69, 14
    s_add_u32 s57, s57, s60
    buffer_load_dwordx4 v[236:239], v9, s[32:35], s57 offen offset:3072 sc1
    s_waitcnt vmcnt(14)
    s_waitcnt lgkmcnt(8)
    v_mfma_f32_32x32x16_bf16 v[68:83], v[44:47], v[180:183], v[68:83]
    v_mfma_f32_32x32x16_bf16 v[84:99], v[48:51], v[180:183], v[84:99]
    ds_read_b64_tr_b16 v[36:37], v19 offset:16384
    ds_read_b64_tr_b16 v[38:39], v19 offset:17408
    ds_read_b64_tr_b16 v[40:41], v20 offset:16384
    ds_read_b64_tr_b16 v[42:43], v20 offset:17408
    s_lshl_b32 s57, s70, 14
    s_add_u32 s57, s57, s60
    buffer_load_dwordx4 v[240:243], v9, s[32:35], s57 offen offset:0 sc1
    s_waitcnt vmcnt(14)
    s_waitcnt lgkmcnt(8)
    v_mfma_f32_32x32x16_bf16 v[68:83], v[52:55], v[184:187], v[68:83]
    v_mfma_f32_32x32x16_bf16 v[84:99], v[56:59], v[184:187], v[84:99]
    ds_read_b64_tr_b16 v[44:45], v19 offset:18432
    ds_read_b64_tr_b16 v[46:47], v19 offset:19456
    ds_read_b64_tr_b16 v[48:49], v20 offset:18432
    ds_read_b64_tr_b16 v[50:51], v20 offset:19456
    s_lshl_b32 s57, s70, 14
    s_add_u32 s57, s57, s60
    buffer_load_dwordx4 v[244:247], v9, s[32:35], s57 offen offset:1024 sc1
    s_waitcnt vmcnt(14)
    s_waitcnt lgkmcnt(8)
    v_mfma_f32_32x32x16_bf16 v[68:83], v[60:63], v[188:191], v[68:83]
    v_mfma_f32_32x32x16_bf16 v[84:99], v[64:67], v[188:191], v[84:99]
    ds_read_b64_tr_b16 v[52:53], v19 offset:20480
    ds_read_b64_tr_b16 v[54:55], v19 offset:21504
    ds_read_b64_tr_b16 v[56:57], v20 offset:20480
    ds_read_b64_tr_b16 v[58:59], v20 offset:21504
    s_lshl_b32 s57, s70, 14
    s_add_u32 s57, s57, s60
    buffer_load_dwordx4 v[248:251], v9, s[32:35], s57 offen offset:2048 sc1
    s_waitcnt vmcnt(14)
    s_waitcnt lgkmcnt(8)
    v_mfma_f32_32x32x16_bf16 v[68:83], v[36:39], v[192:195], v[68:83]
    v_mfma_f32_32x32x16_bf16 v[84:99], v[40:43], v[192:195], v[84:99]
    ds_read_b64_tr_b16 v[60:61], v19 offset:22528
    ds_read_b64_tr_b16 v[62:63], v19 offset:23552
    ds_read_b64_tr_b16 v[64:65], v20 offset:22528
    ds_read_b64_tr_b16 v[66:67], v20 offset:23552
    s_lshl_b32 s57, s70, 14
    s_add_u32 s57, s57, s60
    buffer_load_dwordx4 v[252:255], v9, s[32:35], s57 offen offset:3072 sc1
    s_waitcnt vmcnt(14)
    s_waitcnt lgkmcnt(8)
    v_mfma_f32_32x32x16_bf16 v[68:83], v[44:47], v[196:199], v[68:83]
    v_mfma_f32_32x32x16_bf16 v[84:99], v[48:51], v[196:199], v[84:99]
    ds_read_b64_tr_b16 v[36:37], v15 offset:0
    ds_read_b64_tr_b16 v[38:39], v15 offset:1024
    ds_read_b64_tr_b16 v[40:41], v16 offset:0
    ds_read_b64_tr_b16 v[42:43], v16 offset:1024
    s_waitcnt vmcnt(13)
    s_waitcnt lgkmcnt(8)
    v_mfma_f32_32x32x16_bf16 v[68:83], v[52:55], v[200:203], v[68:83]
    v_mfma_f32_32x32x16_bf16 v[84:99], v[56:59], v[200:203], v[84:99]
    ds_read_b64_tr_b16 v[44:45], v15 offset:2048
    ds_read_b64_tr_b16 v[46:47], v15 offset:3072
    ds_read_b64_tr_b16 v[48:49], v16 offset:2048
    ds_read_b64_tr_b16 v[50:51], v16 offset:3072
    s_waitcnt vmcnt(12)
    s_waitcnt lgkmcnt(8)
    v_mfma_f32_32x32x16_bf16 v[68:83], v[60:63], v[204:207], v[68:83]
    v_mfma_f32_32x32x16_bf16 v[84:99], v[64:67], v[204:207], v[84:99]
    ds_read_b64_tr_b16 v[52:53], v15 offset:4096
    ds_read_b64_tr_b16 v[54:55], v15 offset:5120
    ds_read_b64_tr_b16 v[56:57], v16 offset:4096
    ds_read_b64_tr_b16 v[58:59], v16 offset:5120
    s_waitcnt vmcnt(11)
    s_waitcnt lgkmcnt(8)
    v_mfma_f32_32x32x16_bf16 v[68:83], v[36:39], v[208:211], v[68:83]
    v_mfma_f32_32x32x16_bf16 v[84:99], v[40:43], v[208:211], v[84:99]
    ds_read_b64_tr_b16 v[60:61], v15 offset:6144
    ds_read_b64_tr_b16 v[62:63], v15 offset:7168
    ds_read_b64_tr_b16 v[64:65], v16 offset:6144
    ds_read_b64_tr_b16 v[66:67], v16 offset:7168
    s_barrier
    s_waitcnt vmcnt(10)
    s_waitcnt lgkmcnt(8)
    v_mfma_f32_32x32x16_bf16 v[68:83], v[44:47], v[212:215], v[68:83]
    v_mfma_f32_32x32x16_bf16 v[84:99], v[48:51], v[212:215], v[84:99]
    ds_read_b64_tr_b16 v[36:37], v17 offset:32768
    ds_read_b64_tr_b16 v[38:39], v17 offset:33792
    ds_read_b64_tr_b16 v[40:41], v18 offset:32768
    ds_read_b64_tr_b16 v[42:43], v18 offset:33792
    s_waitcnt vmcnt(9)
    s_waitcnt lgkmcnt(8)
    v_mfma_f32_32x32x16_bf16 v[68:83], v[52:55], v[216:219], v[68:83]
    v_mfma_f32_32x32x16_bf16 v[84:99], v[56:59], v[216:219], v[84:99]
    ds_read_b64_tr_b16 v[44:45], v17 offset:34816
    ds_read_b64_tr_b16 v[46:47], v17 offset:35840
    ds_read_b64_tr_b16 v[48:49], v18 offset:34816
    ds_read_b64_tr_b16 v[50:51], v18 offset:35840
    s_waitcnt vmcnt(8)
    s_waitcnt lgkmcnt(8)
    v_mfma_f32_32x32x16_bf16 v[68:83], v[60:63], v[220:223], v[68:83]
    v_mfma_f32_32x32x16_bf16 v[84:99], v[64:67], v[220:223], v[84:99]
    ds_read_b64_tr_b16 v[52:53], v17 offset:36864
    ds_read_b64_tr_b16 v[54:55], v17 offset:37888
    ds_read_b64_tr_b16 v[56:57], v18 offset:36864
    ds_read_b64_tr_b16 v[58:59], v18 offset:37888
    s_waitcnt vmcnt(7)
    s_waitcnt lgkmcnt(8)
    v_mfma_f32_32x32x16_bf16 v[68:83], v[36:39], v[224:227], v[68:83]
    v_mfma_f32_32x32x16_bf16 v[84:99], v[40:43], v[224:227], v[84:99]
    ds_read_b64_tr_b16 v[60:61], v17 offset:38912
    ds_read_b64_tr_b16 v[62:63], v17 offset:39936
    ds_read_b64_tr_b16 v[64:65], v18 offset:38912
    ds_read_b64_tr_b16 v[66:67], v18 offset:39936
    s_waitcnt vmcnt(6)
    s_waitcnt lgkmcnt(8)
    v_mfma_f32_32x32x16_bf16 v[68:83], v[44:47], v[228:231], v[68:83]
    v_mfma_f32_32x32x16_bf16 v[84:99], v[48:51], v[228:231], v[84:99]
    ds_read_b64_tr_b16 v[36:37], v15 offset:32768
    ds_read_b64_tr_b16 v[38:39], v15 offset:33792
    ds_read_b64_tr_b16 v[40:41], v16 offset:32768
    ds_read_b64_tr_b16 v[42:43], v16 offset:33792
    s_waitcnt vmcnt(5)
    s_waitcnt lgkmcnt(8)
    v_mfma_f32_32x32x16_bf16 v[68:83], v[52:55], v[232:235], v[68:83]
    v_mfma_f32_32x32x16_bf16 v[84:99], v[56:59], v[232:235], v[84:99]
    ds_read_b64_tr_b16 v[44:45], v15 offset:34816
    ds_read_b64_tr_b16 v[46:47], v15 offset:35840
    ds_read_b64_tr_b16 v[48:49], v16 offset:34816
    ds_read_b64_tr_b16 v[50:51], v16 offset:35840
    s_barrier
    ds_read_b128 v[100:103], v134 offset:0
    ds_read_b128 v[104:107], v134 offset:1024
    ds_read_b128 v[108:111], v134 offset:2048
    ds_read_b128 v[112:115], v134 offset:3072
    ds_read_b128 v[116:119], v135 offset:0
    ds_read_b128 v[120:123], v135 offset:1024
    ds_read_b128 v[124:127], v135 offset:2048
    ds_read_b128 v[128:131], v135 offset:3072
    s_waitcnt vmcnt(4)
    s_waitcnt lgkmcnt(15)
    v_mfma_f32_32x32x16_bf16 v[68:83], v[60:63], v[236:239], v[68:83]
    v_mfma_f32_32x32x16_bf16 v[84:99], v[64:67], v[236:239], v[84:99]
    ds_read_b64_tr_b16 v[52:53], v15 offset:36864
    ds_read_b64_tr_b16 v[54:55], v15 offset:37888
    ds_read_b64_tr_b16 v[56:57], v16 offset:36864
    ds_read_b64_tr_b16 v[58:59], v16 offset:37888
    s_waitcnt vmcnt(3)
    s_waitcnt lgkmcnt(15)
    v_mfma_f32_32x32x16_bf16 v[68:83], v[36:39], v[240:243], v[68:83]
    v_mfma_f32_32x32x16_bf16 v[84:99], v[40:43], v[240:243], v[84:99]
    ds_read_b64_tr_b16 v[60:61], v15 offset:38912
    ds_read_b64_tr_b16 v[62:63], v15 offset:39936
    ds_read_b64_tr_b16 v[64:65], v16 offset:38912
    ds_read_b64_tr_b16 v[66:67], v16 offset:39936
    s_waitcnt vmcnt(2)
    s_waitcnt lgkmcnt(15)
    v_mfma_f32_32x32x16_bf16 v[68:83], v[44:47], v[244:247], v[68:83]
    v_mfma_f32_32x32x16_bf16 v[84:99], v[48:51], v[244:247], v[84:99]
    s_waitcnt lgkmcnt(8)
    v_add_f32 v100, v100, v116
    v_add_f32 v101, v101, v117
    v_add_f32 v102, v102, v118
    v_add_f32 v103, v103, v119
    v_add_f32 v104, v104, v120
    v_add_f32 v105, v105, v121
    v_add_f32 v106, v106, v122
    v_add_f32 v107, v107, v123
    v_add_f32 v108, v108, v124
    v_add_f32 v109, v109, v125
    v_add_f32 v110, v110, v126
    v_add_f32 v111, v111, v127
    v_add_f32 v112, v112, v128
    v_add_f32 v113, v113, v129
    v_add_f32 v114, v114, v130
    v_add_f32 v115, v115, v131
    s_waitcnt vmcnt(1)
    s_waitcnt lgkmcnt(4)
    v_mfma_f32_32x32x16_bf16 v[68:83], v[52:55], v[248:251], v[68:83]
    v_mfma_f32_32x32x16_bf16 v[84:99], v[56:59], v[248:251], v[84:99]
    s_waitcnt vmcnt(0)
    s_waitcnt lgkmcnt(0)
    v_mfma_f32_32x32x16_bf16 v[68:83], v[60:63], v[252:255], v[68:83]
    v_mfma_f32_32x32x16_bf16 v[84:99], v[64:67], v[252:255], v[84:99]
    s_cmp_eq_u32 s63, 0
    s_cbranch_scc0 L_k1_10
    s_nop 7
    s_nop 1
    ds_write_b128 v132, v[84:87] offset:0
    ds_write_b128 v132, v[88:91] offset:1024
    ds_write_b128 v132, v[92:95] offset:2048
    ds_write_b128 v132, v[96:99] offset:3072
    v_add_f32 v100, v100, v68
    v_add_f32 v101, v101, v69
    v_add_f32 v102, v102, v70
    v_add_f32 v103, v103, v71
    v_add_f32 v104, v104, v72
    v_add_f32 v105, v105, v73
    v_add_f32 v106, v106, v74
    v_add_f32 v107, v107, v75
    v_add_f32 v108, v108, v76
    v_add_f32 v109, v109, v77
    v_add_f32 v110, v110, v78
    v_add_f32 v111, v111, v79
    v_add_f32 v112, v112, v80
    v_add_f32 v113, v113, v81
    v_add_f32 v114, v114, v82
    v_add_f32 v115, v115, v83
    s_branch L_k2_11
L_k1_10:
    s_nop 7
    s_nop 1
    ds_write_b128 v132, v[68:71] offset:0
    ds_write_b128 v132, v[72:75] offset:1024
    ds_write_b128 v132, v[76:79] offset:2048
    ds_write_b128 v132, v[80:83] offset:3072
    v_add_f32 v100, v100, v84
    v_add_f32 v101, v101, v85
    v_add_f32 v102, v102, v86
    v_add_f32 v103, v103, v87
    v_add_f32 v104, v104, v88
    v_add_f32 v105, v105, v89
    v_add_f32 v106, v106, v90
    v_add_f32 v107, v107, v91
    v_add_f32 v108, v108, v92
    v_add_f32 v109, v109, v93
    v_add_f32 v110, v110, v94
    v_add_f32 v111, v111, v95
    v_add_f32 v112, v112, v96
    v_add_f32 v113, v113, v97
    v_add_f32 v114, v114, v98
    v_add_f32 v115, v115, v99
L_k2_11:
    s_waitcnt lgkmcnt(0)
    s_barrier
    ds_read_b128 v[116:119], v133 offset:0
    ds_read_b128 v[120:123], v133 offset:1024
    ds_read_b128 v[124:127], v133 offset:2048
    ds_read_b128 v[128:131], v133 offset:3072
    s_waitcnt lgkmcnt(3)
    v_add_f32 v68, v100, v116
    v_add_f32 v69, v101, v117
    v_add_f32 v70, v102, v118
    v_add_f32 v71, v103, v119
    s_waitcnt lgkmcnt(2)
    v_add_f32 v72, v104, v120
    v_add_f32 v73, v105, v121
    v_add_f32 v74, v106, v122
    v_add_f32 v75, v107, v123
    s_waitcnt lgkmcnt(1)
    v_add_f32 v76, v108, v124
    v_add_f32 v77, v109, v125
    v_add_f32 v78, v110, v126
    v_add_f32 v79, v111, v127
    s_waitcnt lgkmcnt(0)
    v_add_f32 v80, v112, v128
    v_add_f32 v81, v113, v129
    v_add_f32 v82, v114, v130
    v_add_f32 v83, v115, v131
    v_cvt_pk_bf16_f32 v40, v68, v69
    v_cvt_pk_bf16_f32 v41, v70, v71
    v_cvt_pk_bf16_f32 v42, v72, v73
    v_cvt_pk_bf16_f32 v43, v74, v75
    v_cvt_pk_bf16_f32 v44, v76, v77
    v_cvt_pk_bf16_f32 v45, v78, v79
    v_cvt_pk_bf16_f32 v46, v80, v81
    v_cvt_pk_bf16_f32 v47, v82, v83
    s_nop 1
    v_permlane32_swap_b32 v40, v42
    v_permlane32_swap_b32 v41, v43
    v_permlane32_swap_b32 v44, v46
    v_permlane32_swap_b32 v45, v47
    buffer_store_dwordx4 v[40:43], v136, s[40:43], s56 offen
    buffer_store_dwordx4 v[44:47], v136, s[40:43], s56 offen offset:32
L_done:
    s_endpgm
L_helper:
    v_mul_u32_u24 v1, 896, v0
    v_lshrrev_b32 v4, 3, v0
    v_and_b32 v5, 7, v0
    v_min_u32 v5, 6, v5
    v_mul_u32_u24 v2, 3584, v4
    v_lshl_add_u32 v2, v5, 8, v2
    v_mul_u32_u24 v3, 896, v4
    v_lshl_add_u32 v3, v5, 7, v3
    s_and_b32 s20, s2, 7
    s_lshr_b32 s21, s2, 3
    s_lshl_b32 s21, s21, 3
    s_add_u32 s21, s21, s44
    s_waitcnt lgkmcnt(0)
    s_cmp_lg_u32 s2, 0
    s_cbranch_scc1 L_h0
    s_cmp_lg_u32 s44, 7
    s_cbranch_scc1 L_h0
    s_add_u32 s24, s16, 0x900000
    s_addc_u32 s25, s17, 0
    s_load_dword s22, s[24:25], 0
    s_waitcnt lgkmcnt(0)
    s_add_u32 s22, s22, 1
    s_cmp_eq_u32 s22, 0
    s_cselect_b32 s22, 1, s22
    v_mov_b32 v6, s22
    v_mov_b32 v7, 0
    s_mov_b64 exec, 1
    global_store_dword v7, v6, s[14:15] sc0 sc1
    global_store_dword v7, v6, s[24:25] sc0 sc1
    s_mov_b64 exec, -1
L_h0:
    s_lshr_b32 s23, s20, 2
    s_mul_i32 s23, s23, 917504
    s_and_b32 s26, s20, 3
    s_mul_i32 s26, s26, 7
    s_lshr_b32 s26, s26, 1
    s_lshl_b32 s26, s26, 8
    v_lshrrev_b32 v4, 2, v0
    v_and_b32 v5, 3, v0
    v_mul_u32_u24 v2, 3584, v4
    v_lshl_add_u32 v2, v5, 8, v2
    s_add_u32 s28, s4, s23
    s_addc_u32 s29, s5, 0
    s_add_u32 s30, s6, s26
    s_addc_u32 s31, s7, 0
    s_add_u32 s32, s8, s26
    s_addc_u32 s33, s9, 0
    s_lshl_b32 s27, s20, 4
    s_add_u32 s27, s27, 128
    v_mov_b32 v9, s27
L_hw_0:
    global_load_dword v10, v9, s[14:15] sc1
    s_waitcnt vmcnt(0)
    v_readfirstlane_b32 s27, v10
    s_cmp_lg_u32 s27, 0
    s_cbranch_scc1 L_hx_0
    s_sleep 4
    s_branch L_hw_0
L_hx_0:
    s_add_u32 s34, s21, 112
L_p2_1:
    s_lshr_b32 s35, s34, 4
    s_cmp_ge_u32 s35, 7
    s_cselect_b32 s36, 64, 0
    s_cselect_b32 s37, 7, 0
    s_sub_u32 s35, s35, s37
    s_lshl_b32 s35, s35, 8
    s_add_u32 s35, s35, s36
    s_bfe_u32 s36, s34, 0x10003
    s_lshl_b32 s36, s36, 7
    s_add_u32 s35, s35, s36
    s_and_b32 s36, s34, 7
    s_lshl_b32 s36, s36, 3
    s_add_u32 s35, s35, s36
    s_mul_i32 s35, s35, 896
    s_add_u32 s38, s10, s35
    s_addc_u32 s39, s11, 0
    global_load_dword v8, v3, s[38:39]
    s_add_u32 s34, s34, 32
    s_cmp_lt_u32 s34, 224
    s_cbranch_scc1 L_p2_1
    s_endpgm
L_end:
.section .rodata,"a"
.p2align 6
.amdhsa_kernel standalone__geglu_ffn__prompt_kernel
  .amdhsa_next_free_vgpr 256
  .amdhsa_next_free_sgpr 102
  .amdhsa_accum_offset 256
  .amdhsa_group_segment_fixed_size 0
  .amdhsa_kernarg_size 56
  .amdhsa_user_sgpr_count 2
  .amdhsa_user_sgpr_kernarg_segment_ptr 1
  .amdhsa_system_sgpr_workgroup_id_x 1
.end_amdhsa_kernel
```
